```python
import torch

def _softmax(x, axis=-1):
    return torch.softmax(x, dim=axis)
def _gelu(x):
    return torch.nn.functional.gelu(x, approximate="tanh")
def _silu(x):
    return torch.nn.functional.silu(x)
def _sigmoid(x):
    return torch.sigmoid(x)
def _layernorm(x, axis=-1, eps=1e-5):
    m = x.mean(dim=axis, keepdim=True)
    v = x.var(dim=axis, keepdim=True, unbiased=False)
    return (x - m) / torch.sqrt(v + eps)
def _scatter_add(tgt, idx, src, axis=0):
    return tgt.clone().index_add_(axis, idx, src)
def _segment_sum(src, seg, n):
    out = torch.zeros((n,) + src.shape[1:], dtype=src.dtype)
    return out.index_add_(0, seg, src)
def _pad(x, pw):
    flat = tuple(v for pair in reversed(pw) for v in pair)
    return torch.nn.functional.pad(x, flat)

kernel_name = 'standalone__edge_featured_mpnn_egc__graph'

def setup_inputs():

    _w = (lambda a: (lambda t: t.to(torch.bfloat16) if t.is_floating_point() else t)(torch.as_tensor(a)))
    N, deg, D, De = 12500, 64, 64, max(4, 1)
    E = N * deg
    return {
        "x": _w((lambda *s: torch.randn(*s, dtype=torch.bfloat16) * 0.2)(N, D)),
        "e_attr": _w((lambda *s: torch.randn(*s, dtype=torch.bfloat16) * 0.2)(E, De)),
        "src": _w((lambda lo, hi, *s: torch.randint(lo, hi, s))(0, N, E).to(torch.int64)),
        "dst": _w((lambda lo, hi, *s: torch.randint(lo, hi, s))(0, N, E).to(torch.int64)),
        "u_w": _w((lambda *s: torch.randn(*s, dtype=torch.bfloat16) * 0.05)(D, D)),
        "v_w": _w((lambda *s: torch.randn(*s, dtype=torch.bfloat16) * 0.05)(D, D)),
        "g_w": _w((lambda *s: torch.randn(*s, dtype=torch.bfloat16) * 0.2)(2 * D + De, D)),
    }

def reference(x, e_attr, src, dst, u_w, v_w, g_w):
    N, D = x.shape
    g_in = torch.concatenate([x[dst], x[src], e_attr], axis=-1)
    eta = _sigmoid(g_in @ g_w)
    hv = x @ v_w
    msg = eta * hv[src]
    agg = _segment_sum(msg, dst, N)
    return _silu(x @ u_w + agg)
```

```asm
; @launch grid=(256,1,1) block=(1024,1,1) lds=152576
.amdgcn_target "amdgcn-amd-amdhsa--gfx950"
.text
.globl standalone__edge_featured_mpnn_egc__graph_kernel
.p2align 8
.type standalone__edge_featured_mpnn_egc__graph_kernel,@function
standalone__edge_featured_mpnn_egc__graph_kernel:
    s_cmp_ge_u32 s2, 256
    s_cbranch_scc1 L_end
    s_load_dwordx16 s[80:95], s[0:1], 0
    s_load_dwordx4 s[96:99], s[0:1], 64
    s_getpc_b64 s[8:9]
L_pc:
    s_and_b32 s9, s9, 0xffff
    s_mov_b32 s10, L_codeend-L_pc
    s_mov_b32 s11, 0x00020000
    s_lshr_b32 s4, s2, 3
    s_lshl_b32 s4, s4, 10
    v_lshl_add_u32 v1, v0, 4, s4
    v_cmp_gt_u32 vcc, 64, v0
    s_and_saveexec_b64 s[4:5], vcc
    s_cbranch_execz L_npf
    buffer_load_dwordx4 v[120:123], v1, s[8:11], 0 offen
L_npf:
    s_mov_b64 exec, -1
    v_lshrrev_b32 v1, 6, v0
    v_and_b32 v10, 63, v0
    s_movk_i32 s4, 768
    s_cmp_eq_u32 s2, 255
    s_cselect_b32 s4, 590, s4
    s_cselect_b32 s6, 0, 56
    v_readfirstlane_b32 s3, v1
    s_mul_i32 s5, s2, 12512
    v_subrev_u32 v4, 256, v0
    v_lshl_add_u32 v2, v4, 4, s5
    v_lshlrev_b32 v3, 1, v2
    v_cmp_gt_u32 s[72:73], s4, v4
    v_cmp_gt_u32 s[74:75], s6, v4
    s_and_b32 s30, s2, 7
    s_lshl_b32 s30, s30, 5
    s_lshr_b32 s31, s2, 3
    s_add_u32 s30, s30, s31
    s_mul_i32 s78, s30, 49
    v_lshlrev_b32 v7, 4, v0
    s_add_u32 s5, s5, 12288
    v_lshl_add_u32 v5, v4, 2, s5
    s_mov_b32 s38, 3200000
    s_mov_b32 s39, 0x00020000
    s_waitcnt lgkmcnt(0)
    s_mov_b32 s36, s86
    s_and_b32 s37, s87, 0xffff
    s_mov_b64 exec, s[72:73]
    s_cbranch_execz L1_noload
    buffer_load_dwordx4 v[64:67], v2, s[36:39], 0 offen nt
    s_mov_b64 exec, s[74:75]
    s_cbranch_execz L1_noload
    buffer_load_dword v80, v5, s[36:39], 0 offen nt
L1_noload:
    s_mov_b64 exec, -1
    s_cmp_gt_u32 s3, 3
    s_cbranch_scc1 L1_a
    s_mov_b32 s48, s80
    s_and_b32 s49, s81, 0xffff
    s_mov_b32 s50, 1600000
    s_mov_b32 s51, 0x00020000
    v_lshlrev_b32 v25, 4, v10
    s_lshl_b32 s4, s3, 11
    s_lshl_b32 s5, s78, 7
    s_add_u32 s5, s5, s4
    s_add_u32 s4, s4, 93696
    s_mov_b32 m0, s4
    v_add_u32 v20, s5, v25
    s_and_b32 s6, s3, 1
    s_lshr_b32 s7, s3, 1
    buffer_load_dwordx4 v20, s[48:51], 0 offen nt lds
    buffer_load_dwordx4 v20, s[48:51], 0 offen offset:1024 nt lds
    s_cmp_eq_u32 s7, 0
    s_cselect_b32 s52, s92, s90
    s_cselect_b32 s53, s93, s91
    s_cselect_b32 s5, 8192, 0
    s_and_b32 s53, s53, 0xffff
    s_add_u32 s54, s5, 8192
    s_mov_b32 s55, 0x00020000
    s_lshl_b32 s4, s6, 12
    s_add_u32 s5, s5, s4
    s_lshl_b32 s4, s3, 12
    s_add_u32 s4, s4, 101888
    s_mov_b32 m0, s4
    s_cmp_lg_u32 s3, 2
    buffer_load_dwordx4 v25, s[52:55], s5 offen offset:0  lds
    buffer_load_dwordx4 v25, s[52:55], s5 offen offset:1024  lds
    buffer_load_dwordx4 v25, s[52:55], s5 offen offset:2048  lds
    buffer_load_dwordx4 v25, s[52:55], s5 offen offset:3072  lds
    s_cbranch_scc1 L1_a
    v_mov_b32 v32, 0
    v_mov_b32 v33, 0
    v_mov_b32 v34, 0
    v_mov_b32 v35, 0
    ds_write_b128 v25, v[32:35] offset:38912
    v_lshlrev_b32 v26, 2, v10
    v_add_u32 v26, 151040, v26
    ds_write_b32 v26, v32
    ds_write_b32 v26, v32 offset:64
    s_waitcnt lgkmcnt(0)
L1_a:
    s_mov_b32 s40, s84
    s_and_b32 s41, s85, 0xffff
    s_mov_b32 s42, 3200000
    s_mov_b32 s43, 0x00020000
    s_mov_b32 s44, s82
    s_and_b32 s45, s83, 0xffff
    s_mov_b32 s46, 6400000
    s_mov_b32 s47, 0x00020000
    s_barrier
    s_mov_b64 exec, s[72:73]
    s_cbranch_execz L1_noload2
    buffer_load_dwordx4 v[68:71], v2, s[40:43], 0 offen nt
    buffer_load_dwordx4 v[72:75], v3, s[44:47], 0 offen nt
    buffer_load_dwordx4 v[76:79], v3, s[44:47], 0 offen offset:16 nt
    s_mov_b64 exec, s[74:75]
    s_cbranch_execz L1_noload2
    v_lshlrev_b32 v3, 1, v5
    buffer_load_dword v81, v5, s[40:43], 0 offen nt
    buffer_load_dwordx2 v[82:83], v3, s[44:47], 0 offen nt
L1_noload2:
    s_mov_b64 exec, -1
    s_mov_b32 s12, s98
    s_and_b32 s13, s99, 0xffff
    s_mov_b32 s14, 15794176
    s_mov_b32 s15, 0x00020000
    s_mov_b32 s16, s94
    s_and_b32 s17, s95, 0xffff
    s_mov_b32 s18, 1600000
    s_mov_b32 s19, 0x00020000
    s_mov_b32 s68, s96
    s_and_b32 s69, s97, 0xffff
    s_mov_b32 s70, 256
    s_mov_b32 s71, 0x00020000
    s_mov_b32 s52, s92
    s_and_b32 s53, s93, 0xffff
    s_mov_b32 s54, 16896
    s_mov_b32 s55, 0x00020000
    s_mov_b32 s60, s88
    s_and_b32 s61, s89, 0xffff
    s_mov_b32 s62, 8192
    s_mov_b32 s63, 0x00020000
    s_add_u32 s8, s98, 12582912
    s_addc_u32 s9, s99, 0
    s_and_b32 s9, s9, 0xffff
    s_or_b32 s9, s9, 0x40000
    s_mov_b32 s10, 3211264
    s_mov_b32 s11, 0x00800000
    s_cmp_gt_u32 s3, 3
    s_cbranch_scc1 L1_edge
    s_lshl_b32 s29, s3, 12
    s_add_u32 s29, s29, 118272
    v_and_b32 v24, 31, v10
    v_lshrrev_b32 v25, 5, v10
    s_lshl_b32 s84, s7, 12
    s_add_u32 s84, s84, 93696
    v_lshl_add_u32 v20, v25, 4, s84
    v_lshl_add_u32 v20, v24, 7, v20
    v_lshlrev_b32 v27, 9, v25
    v_lshl_add_u32 v27, v24, 2, v27
    v_add_u32 v27, s29, v27
    v_bfe_u32 v28, v10, 2, 2
    v_lshl_add_u32 v26, v25, 3, v28
    v_lshlrev_b32 v26, 7, v26
    v_bfe_u32 v28, v10, 4, 1
    v_lshl_add_u32 v26, v28, 5, v26
    v_and_b32 v28, 3, v10
    v_lshl_add_u32 v26, v28, 3, v26
    s_lshl_b32 s84, s6, 6
    s_add_u32 s84, s84, 101888
    v_add_u32 v26, s84, v26
    v_lshrrev_b32 v21, 3, v10
    v_and_b32 v22, 7, v10
    v_lshlrev_b32 v22, 4, v22
    s_lshl_b32 s84, s7, 5
    v_add_u32 v23, s84, v21
    v_lshl_add_u32 v29, v23, 8, v22
    v_lshl_add_u32 v21, v21, 7, v22
    v_add_u32 v21, s29, v21
    s_lshl_b32 s84, s3, 12
    s_add_u32 s85, s84, 134656
    s_mov_b32 m0, s85
    v_lshlrev_b32 v28, 4, v10
    s_waitcnt vmcnt(0)
    s_cmp_lg_u32 s3, 1
    s_cbranch_scc1 L1_nn
    s_cmp_lg_u32 s2, 0
    s_cbranch_scc1 L1_nn
    s_memrealtime s[84:85]
    s_waitcnt lgkmcnt(0)
    s_lshl_b32 s86, s84, 24
    s_lshr_b64 s[84:85], s[84:85], 8
    s_bitset1_b32 s84, 31
    v_mov_b32 v32, s86
    v_mov_b32 v33, s84
    v_mov_b32 v34, 0
    s_mov_b64 exec, 1
    buffer_store_dwordx2 v[32:33], v34, s[68:71], 0 offen sc1
    s_mov_b64 exec, -1
L1_nn:
    s_cmp_lg_u32 s3, 2
    s_cbranch_scc1 L1_nz
    v_mov_b32 v32, 0
    s_mul_i32 s88, s2, 37536
    s_lshl_b32 s89, s78, 8
    s_add_u32 s89, s89, 12582912
    s_mov_b32 s90, 10485760
    buffer_load_dword v33, v32, s[12:15], s88 offen sc1
    buffer_load_dword v33, v32, s[12:15], s89 offen sc1
    buffer_load_dword v33, v32, s[12:15], s90 offen sc1
    s_add_u32 s88, s88, 37532
    buffer_load_dword v33, v32, s[12:15], s88 offen sc1
    buffer_load_dword v33, v32, s[16:19], 0 offen sc1
L1_nz:
    s_barrier
    s_setprio 2
    ds_read_b128 v[40:43], v20 offset:0
    ds_read_b128 v[44:47], v20 offset:32
    ds_read_b128 v[48:51], v20 offset:64
    ds_read_b128 v[52:55], v20 offset:96
    ds_read_b64_tr_b16 v[64:65], v26 offset:0
    ds_read_b64_tr_b16 v[66:67], v26 offset:512
    ds_read_b64_tr_b16 v[68:69], v26 offset:2048
    ds_read_b64_tr_b16 v[70:71], v26 offset:2560
    ds_read_b64_tr_b16 v[72:73], v26 offset:4096
    ds_read_b64_tr_b16 v[74:75], v26 offset:4608
    ds_read_b64_tr_b16 v[76:77], v26 offset:6144
    ds_read_b64_tr_b16 v[78:79], v26 offset:6656
    ds_read_b64_tr_b16 v[80:81], v26 offset:8192
    ds_read_b64_tr_b16 v[82:83], v26 offset:8704
    ds_read_b64_tr_b16 v[84:85], v26 offset:10240
    ds_read_b64_tr_b16 v[86:87], v26 offset:10752
    ds_read_b64_tr_b16 v[88:89], v26 offset:12288
    ds_read_b64_tr_b16 v[90:91], v26 offset:12800
    ds_read_b64_tr_b16 v[92:93], v26 offset:14336
    ds_read_b64_tr_b16 v[94:95], v26 offset:14848
    s_lshl_b32 s87, s6, 12
    s_cmp_eq_u32 s7, 0
    s_cbranch_scc0 L1_ldu
    buffer_load_dwordx4 v28, s[52:55], s87 offen offset:0 lds
    buffer_load_dwordx4 v28, s[52:55], s87 offen offset:1024 lds
    buffer_load_dwordx4 v28, s[52:55], s87 offen offset:2048 lds
    buffer_load_dwordx4 v28, s[52:55], s87 offen offset:3072 lds
    s_branch L1_ldd
L1_ldu:
    buffer_load_dwordx4 v28, s[60:63], s87 offen offset:0 lds
    buffer_load_dwordx4 v28, s[60:63], s87 offen offset:1024 lds
    buffer_load_dwordx4 v28, s[60:63], s87 offen offset:2048 lds
    buffer_load_dwordx4 v28, s[60:63], s87 offen offset:3072 lds
L1_ldd:
    s_mov_b32 s84, 0xffff0000
    s_mov_b32 s85, 0xbfb8aa3b
    s_brev_b32 s86, 1
    s_waitcnt lgkmcnt(8)
    v_mfma_f32_32x32x16_bf16 v[96:111], v[40:43], v[64:67], 0
    v_mfma_f32_32x32x16_bf16 v[96:111], v[44:47], v[68:71], v[96:111]
    v_mfma_f32_32x32x16_bf16 v[96:111], v[48:51], v[72:75], v[96:111]
    v_mfma_f32_32x32x16_bf16 v[96:111], v[52:55], v[76:79], v[96:111]
    s_waitcnt lgkmcnt(0)
    v_mfma_f32_32x32x16_bf16 v[112:127], v[40:43], v[80:83], 0
    v_mfma_f32_32x32x16_bf16 v[112:127], v[44:47], v[84:87], v[112:127]
    v_mfma_f32_32x32x16_bf16 v[112:127], v[48:51], v[88:91], v[112:127]
    v_mfma_f32_32x32x16_bf16 v[112:127], v[52:55], v[92:95], v[112:127]
    s_nop 6
    v_mul_f32 v96, s85, v96
    v_mul_f32 v97, s85, v97
    v_mul_f32 v98, s85, v98
    v_mul_f32 v99, s85, v99
    v_mul_f32 v100, s85, v100
    v_mul_f32 v101, s85, v101
    v_mul_f32 v102, s85, v102
    v_mul_f32 v103, s85, v103
    v_mul_f32 v104, s85, v104
    v_mul_f32 v105, s85, v105
    v_mul_f32 v106, s85, v106
    v_mul_f32 v107, s85, v107
    v_mul_f32 v108, s85, v108
    v_mul_f32 v109, s85, v109
    v_mul_f32 v110, s85, v110
    v_mul_f32 v111, s85, v111
    v_cvt_pk_bf16_f32 v96, v96, v97
    v_lshrrev_b32 v97, 16, v96
    v_and_b32 v96, 0xffff, v96
    v_cvt_pk_bf16_f32 v98, v98, v99
    v_lshrrev_b32 v99, 16, v98
    v_and_b32 v98, 0xffff, v98
    v_cvt_pk_bf16_f32 v100, v100, v101
    v_lshrrev_b32 v101, 16, v100
    v_and_b32 v100, 0xffff, v100
    v_cvt_pk_bf16_f32 v102, v102, v103
    v_lshrrev_b32 v103, 16, v102
    v_and_b32 v102, 0xffff, v102
    v_cvt_pk_bf16_f32 v104, v104, v105
    v_lshrrev_b32 v105, 16, v104
    v_and_b32 v104, 0xffff, v104
    v_cvt_pk_bf16_f32 v106, v106, v107
    v_lshrrev_b32 v107, 16, v106
    v_and_b32 v106, 0xffff, v106
    v_cvt_pk_bf16_f32 v108, v108, v109
    v_lshrrev_b32 v109, 16, v108
    v_and_b32 v108, 0xffff, v108
    v_cvt_pk_bf16_f32 v110, v110, v111
    v_lshrrev_b32 v111, 16, v110
    v_and_b32 v110, 0xffff, v110
    v_add_u32 v56, 0x8000, v112
    v_and_b32 v60, s86, v112
    v_sub_u32_e64 v56, v56, v96 clamp
    v_max_u32 v56, v56, v60
    v_and_or_b32 v56, v56, s84, v96
    ds_write_b32 v27, v56 offset:0
    v_add_u32 v57, 0x8000, v113
    v_and_b32 v61, s86, v113
    v_sub_u32_e64 v57, v57, v97 clamp
    v_max_u32 v57, v57, v61
    v_and_or_b32 v57, v57, s84, v97
    ds_write_b32 v27, v57 offset:128
    v_add_u32 v58, 0x8000, v114
    v_and_b32 v62, s86, v114
    v_sub_u32_e64 v58, v58, v98 clamp
    v_max_u32 v58, v58, v62
    v_and_or_b32 v58, v58, s84, v98
    ds_write_b32 v27, v58 offset:256
    v_add_u32 v59, 0x8000, v115
    v_and_b32 v63, s86, v115
    v_sub_u32_e64 v59, v59, v99 clamp
    v_max_u32 v59, v59, v63
    v_and_or_b32 v59, v59, s84, v99
    ds_write_b32 v27, v59 offset:384
    v_add_u32 v56, 0x8000, v116
    v_and_b32 v60, s86, v116
    v_sub_u32_e64 v56, v56, v100 clamp
    v_max_u32 v56, v56, v60
    v_and_or_b32 v56, v56, s84, v100
    ds_write_b32 v27, v56 offset:1024
    v_add_u32 v57, 0x8000, v117
    v_and_b32 v61, s86, v117
    v_sub_u32_e64 v57, v57, v101 clamp
    v_max_u32 v57, v57, v61
    v_and_or_b32 v57, v57, s84, v101
    ds_write_b32 v27, v57 offset:1152
    v_add_u32 v58, 0x8000, v118
    v_and_b32 v62, s86, v118
    v_sub_u32_e64 v58, v58, v102 clamp
    v_max_u32 v58, v58, v62
    v_and_or_b32 v58, v58, s84, v102
    ds_write_b32 v27, v58 offset:1280
    v_add_u32 v59, 0x8000, v119
    v_and_b32 v63, s86, v119
    v_sub_u32_e64 v59, v59, v103 clamp
    v_max_u32 v59, v59, v63
    v_and_or_b32 v59, v59, s84, v103
    ds_write_b32 v27, v59 offset:1408
    v_add_u32 v56, 0x8000, v120
    v_and_b32 v60, s86, v120
    v_sub_u32_e64 v56, v56, v104 clamp
    v_max_u32 v56, v56, v60
    v_and_or_b32 v56, v56, s84, v104
    ds_write_b32 v27, v56 offset:2048
    v_add_u32 v57, 0x8000, v121
    v_and_b32 v61, s86, v121
    v_sub_u32_e64 v57, v57, v105 clamp
    v_max_u32 v57, v57, v61
    v_and_or_b32 v57, v57, s84, v105
    ds_write_b32 v27, v57 offset:2176
    v_add_u32 v58, 0x8000, v122
    v_and_b32 v62, s86, v122
    v_sub_u32_e64 v58, v58, v106 clamp
    v_max_u32 v58, v58, v62
    v_and_or_b32 v58, v58, s84, v106
    ds_write_b32 v27, v58 offset:2304
    v_add_u32 v59, 0x8000, v123
    v_and_b32 v63, s86, v123
    v_sub_u32_e64 v59, v59, v107 clamp
    v_max_u32 v59, v59, v63
    v_and_or_b32 v59, v59, s84, v107
    ds_write_b32 v27, v59 offset:2432
    v_add_u32 v56, 0x8000, v124
    v_and_b32 v60, s86, v124
    v_sub_u32_e64 v56, v56, v108 clamp
    v_max_u32 v56, v56, v60
    v_and_or_b32 v56, v56, s84, v108
    ds_write_b32 v27, v56 offset:3072
    v_add_u32 v57, 0x8000, v125
    v_and_b32 v61, s86, v125
    v_sub_u32_e64 v57, v57, v109 clamp
    v_max_u32 v57, v57, v61
    v_and_or_b32 v57, v57, s84, v109
    ds_write_b32 v27, v57 offset:3200
    v_add_u32 v58, 0x8000, v126
    v_and_b32 v62, s86, v126
    v_sub_u32_e64 v58, v58, v110 clamp
    v_max_u32 v58, v58, v62
    v_and_or_b32 v58, v58, s84, v110
    ds_write_b32 v27, v58 offset:3328
    v_add_u32 v59, 0x8000, v127
    v_and_b32 v63, s86, v127
    v_sub_u32_e64 v59, v59, v111 clamp
    v_max_u32 v59, v59, v63
    v_and_or_b32 v59, v59, s84, v111
    ds_write_b32 v27, v59 offset:3456
    ds_read_b128 v[64:67], v21 offset:0
    ds_read_b128 v[68:71], v21 offset:1024
    ds_read_b128 v[72:75], v21 offset:2048
    ds_read_b128 v[76:79], v21 offset:3072
    s_lshl_b32 s84, s78, 8
    s_lshl_b32 s85, s6, 7
    s_add_u32 s84, s84, s85
    s_add_u32 s84, s84, 12582912
    s_waitcnt vmcnt(0)
    v_cmp_gt_u32 vcc, 49, v23
    s_waitcnt lgkmcnt(3)
    s_mov_b64 exec, vcc
    buffer_store_dwordx4 v[64:67], v29, s[12:15], s84 offen sc1
    s_add_u32 s84, s84, 2048
    s_mov_b64 exec, -1
    v_cmp_gt_u32 vcc, 41, v23
    s_waitcnt lgkmcnt(2)
    s_mov_b64 exec, vcc
    buffer_store_dwordx4 v[68:71], v29, s[12:15], s84 offen sc1
    s_add_u32 s84, s84, 2048
    s_mov_b64 exec, -1
    v_cmp_gt_u32 vcc, 33, v23
    s_waitcnt lgkmcnt(1)
    s_mov_b64 exec, vcc
    buffer_store_dwordx4 v[72:75], v29, s[12:15], s84 offen sc1
    s_add_u32 s84, s84, 2048
    s_mov_b64 exec, -1
    v_cmp_gt_u32 vcc, 25, v23
    s_waitcnt lgkmcnt(0)
    s_mov_b64 exec, vcc
    buffer_store_dwordx4 v[76:79], v29, s[12:15], s84 offen sc1
    s_add_u32 s84, s84, 2048
    s_mov_b64 exec, -1
    s_setprio 0
    s_branch L1_d
L1_edge:
    s_mov_b64 exec, s[72:73]
    s_cbranch_execz L1_histdone
    s_movk_i32 s84, 21400
    v_mov_b32 v20, 1
    s_cmp_eq_u64 s[74:75], 0
    s_cbranch_scc1 L1_h4
    s_mov_b64 exec, s[74:75]
    s_waitcnt vmcnt(5)
    v_mul_u32_u24 v88, s84, v80
    v_lshrrev_b32 v88, 20, v88
    v_lshlrev_b32 v93, 2, v88
    ds_add_rtn_u32 v98, v93, v20 offset:38912
    v_mul_u32_u24 v88, 49, v88
    v_sub_u32 v80, v80, v88
    v_lshlrev_b32 v80, 26, v80
    s_mov_b64 exec, s[72:73]
    s_branch L1_h5
L1_h4:
    s_waitcnt vmcnt(3)
L1_h5:
    v_mul_u32_u24 v84, s84, v64
    v_mul_u32_u24 v85, s84, v65
    v_mul_u32_u24 v86, s84, v66
    v_mul_u32_u24 v87, s84, v67
    v_lshrrev_b32 v84, 20, v84
    v_lshrrev_b32 v85, 20, v85
    v_lshrrev_b32 v86, 20, v86
    v_lshrrev_b32 v87, 20, v87
    v_lshlrev_b32 v89, 2, v84
    ds_add_rtn_u32 v94, v89, v20 offset:38912
    v_lshlrev_b32 v90, 2, v85
    ds_add_rtn_u32 v95, v90, v20 offset:38912
    v_lshlrev_b32 v91, 2, v86
    ds_add_rtn_u32 v96, v91, v20 offset:38912
    v_lshlrev_b32 v92, 2, v87
    ds_add_rtn_u32 v97, v92, v20 offset:38912
    v_mul_u32_u24 v84, 49, v84
    v_mul_u32_u24 v85, 49, v85
    v_mul_u32_u24 v86, 49, v86
    v_mul_u32_u24 v87, 49, v87
    v_sub_u32 v64, v64, v84
    v_sub_u32 v65, v65, v85
    v_sub_u32 v66, v66, v86
    v_sub_u32 v67, v67, v87
    v_lshlrev_b32 v64, 26, v64
    v_lshlrev_b32 v65, 26, v65
    v_lshlrev_b32 v66, 26, v66
    v_lshlrev_b32 v67, 26, v67
    s_waitcnt lgkmcnt(0)
L1_histdone:
    s_mov_b64 exec, -1
    v_lshlrev_b32 v104, 4, v10
    s_sub_u32 s85, s3, 3
    s_lshl_b32 s85, s85, 10
    s_add_u32 s85, s85, 77824
    v_add_u32 v105, s85, v104
    v_add_u32 v89, s85, v89
    v_add_u32 v90, s85, v90
    v_add_u32 v91, s85, v91
    v_add_u32 v92, s85, v92
    v_add_u32 v93, s85, v93
    s_barrier
    ds_read_b128 v[108:111], v104 offset:38912
    s_waitcnt lgkmcnt(0)
    v_add_u32 v106, v108, v109
    v_add_u32 v107, v106, v110
    v_add_u32 v116, v107, v111
    v_mov_b32 v112, v116
    s_nop 1
    v_add_u32_dpp v112, v112, v112 row_shr:1 row_mask:0xf bank_mask:0xf bound_ctrl:0
    s_nop 1
    v_add_u32_dpp v112, v112, v112 row_shr:2 row_mask:0xf bank_mask:0xf bound_ctrl:0
    s_nop 1
    v_add_u32_dpp v112, v112, v112 row_shr:4 row_mask:0xf bank_mask:0xf bound_ctrl:0
    s_nop 1
    v_add_u32_dpp v112, v112, v112 row_shr:8 row_mask:0xf bank_mask:0xf bound_ctrl:0
    s_nop 1
    v_add_u32_dpp v112, v112, v112 row_bcast:15 row_mask:0xa bank_mask:0xf
    s_nop 1
    v_add_u32_dpp v112, v112, v112 row_bcast:31 row_mask:0xc bank_mask:0xf
    v_sub_u32 v112, v112, v116
    v_add_u32 v113, v112, v108
    v_add_u32 v114, v112, v106
    v_add_u32 v115, v112, v107
    s_cmp_lg_u32 s3, 15
    s_cbranch_scc1 L1_scat
    v_lshl_or_b32 v108, v108, 12, v112
    v_lshl_or_b32 v109, v109, 12, v113
    v_lshl_or_b32 v110, v110, 12, v114
    v_lshl_or_b32 v111, v111, 12, v115
    v_add_u32 v104, 151552, v104
    ds_write_b128 v104, v[108:111]
L1_scat:
    v_mul_u32_u24 v112, 12, v112
    v_mul_u32_u24 v113, 12, v113
    v_mul_u32_u24 v114, 12, v114
    v_mul_u32_u24 v115, 12, v115
    ds_write_b128 v105, v[112:115]
    s_mov_b64 exec, s[72:73]
    s_cbranch_execz L1_scatdone
    ds_read_b32 v84, v89
    ds_read_b32 v85, v90
    ds_read_b32 v86, v91
    ds_read_b32 v87, v92
    ds_read_b32 v88, v93
    s_waitcnt lgkmcnt(0)
    v_mad_u32_u24 v84, v94, 12, v84
    v_mad_u32_u24 v85, v95, 12, v85
    v_mad_u32_u24 v86, v96, 12, v86
    v_mad_u32_u24 v87, v97, 12, v87
    v_mad_u32_u24 v88, v98, 12, v88
    s_waitcnt vmcnt(2)
    v_lshl_or_b32 v68, v68, 8, v64
    v_lshl_or_b32 v69, v69, 8, v65
    v_lshl_or_b32 v70, v70, 8, v66
    v_lshl_or_b32 v71, v71, 8, v67
    ds_write_b32 v84, v68 offset:39944
    ds_write_b32 v85, v69 offset:39944
    ds_write_b32 v86, v70 offset:39944
    ds_write_b32 v87, v71 offset:39944
    v_add_u32 v84, 39936, v84
    v_add_u32 v85, 39936, v85
    v_add_u32 v86, 39936, v86
    v_add_u32 v87, 39936, v87
    v_add_u32 v88, 39936, v88
    s_waitcnt vmcnt(0)
    ds_write2_b32 v84, v72, v73 offset0:0 offset1:1
    ds_write2_b32 v85, v74, v75 offset0:0 offset1:1
    ds_write2_b32 v86, v76, v77 offset0:0 offset1:1
    ds_write2_b32 v87, v78, v79 offset0:0 offset1:1
    s_mov_b64 exec, s[74:75]
    s_cbranch_execz L1_scatdone
    v_lshl_or_b32 v81, v81, 8, v80
    ds_write_b32 v88, v81 offset:8
    ds_write2_b32 v88, v82, v83 offset0:0 offset1:1
L1_scatdone:
    s_mov_b64 exec, -1
L1_d:
    s_mul_i32 s85, s2, 37536
    v_add_u32 v4, 39936, v7
    v_add_u32 v5, 16384, v7
    v_add_u32 v6, 32768, v7
    v_cmp_gt_u32 vcc, 298, v0
    s_waitcnt lgkmcnt(0)
    s_barrier
    ds_read_b128 v[80:83], v4
    ds_read_b128 v[84:87], v4 offset:16384
    ds_read_b128 v[88:91], v4 offset:32768
    s_waitcnt lgkmcnt(2)
    buffer_store_dwordx4 v[80:83], v7, s[12:15], s85 offen sc1
    s_waitcnt lgkmcnt(1)
    buffer_store_dwordx4 v[84:87], v5, s[12:15], s85 offen sc1
    s_mov_b64 exec, vcc
    s_cbranch_execz L1_c3
    s_waitcnt lgkmcnt(0)
    buffer_store_dwordx4 v[88:91], v6, s[12:15], s85 offen sc1
L1_c3:
    s_mov_b64 exec, -1
    v_lshlrev_b32 v1, 1, v10
    v_add_u32 v1, 0x4000, v1
    buffer_load_ushort v76, v1, s[52:55], 0 offen offset:0
    buffer_load_ushort v77, v1, s[52:55], 0 offen offset:128
    buffer_load_ushort v78, v1, s[52:55], 0 offen offset:256
    buffer_load_ushort v79, v1, s[52:55], 0 offen offset:384
    v_mov_b32 v74, 0
    buffer_load_dwordx2 v[72:73], v74, s[68:71], 0 offen sc1
    v_and_b32 v1, 3, v10
    v_mov_b32 v2, 0x3f80
    v_cmp_eq_u32 vcc, 0, v1
    s_nop 1
    v_cndmask_b32 v26, 0, v2, vcc
    v_cmp_eq_u32 vcc, 1, v1
    s_nop 1
    v_cndmask_b32 v27, 0, v2, vcc
    v_cmp_eq_u32 vcc, 2, v1
    s_nop 1
    v_cndmask_b32 v24, 0, v2, vcc
    v_cmp_eq_u32 vcc, 3, v1
    s_nop 1
    v_cndmask_b32 v25, 0, v2, vcc
    s_cmp_lt_u32 s3, 8
    s_cbranch_scc1 L2_pdone
    s_and_b32 s86, s3, 1
    s_bfe_u32 s91, s3, 0x10001
    s_bfe_u32 s88, s3, 0x10002
    s_lshl_b32 s89, s91, 12
    s_add_u32 s89, s89, 93696
    v_and_b32 v3, 31, v10
    v_lshrrev_b32 v2, 5, v10
    v_lshl_add_u32 v1, v2, 4, s89
    v_lshl_add_u32 v1, v3, 7, v1
    ds_read_b128 v[32:35], v1 offset:0
    ds_read_b128 v[36:39], v1 offset:32
    ds_read_b128 v[40:43], v1 offset:64
    ds_read_b128 v[44:47], v1 offset:96
    s_lshl_b32 s90, s88, 5
    v_add_u32 v3, s90, v3
    v_bfe_u32 v20, v10, 2, 2
    v_lshl_add_u32 v1, v2, 3, v20
    v_lshlrev_b32 v1, 7, v1
    v_bfe_u32 v20, v10, 4, 1
    v_lshl_add_u32 v1, v20, 5, v1
    v_and_b32 v20, 3, v10
    v_lshl_add_u32 v1, v20, 3, v1
    s_lshl_b32 s89, s86, 13
    s_lshl_b32 s90, s88, 6
    s_add_u32 s89, s89, s90
    s_add_u32 s89, s89, 134656
    v_add_u32 v1, s89, v1
    ds_read_b64_tr_b16 v[48:49], v1 offset:0
    ds_read_b64_tr_b16 v[50:51], v1 offset:512
    ds_read_b64_tr_b16 v[52:53], v1 offset:2048
    ds_read_b64_tr_b16 v[54:55], v1 offset:2560
    ds_read_b64_tr_b16 v[56:57], v1 offset:4096
    ds_read_b64_tr_b16 v[58:59], v1 offset:4608
    ds_read_b64_tr_b16 v[60:61], v1 offset:6144
    ds_read_b64_tr_b16 v[62:63], v1 offset:6656
    v_lshlrev_b32 v2, 2, v2
    s_lshl_b32 s90, s91, 5
    v_add_u32 v2, s90, v2
    v_lshl_add_u32 v2, v2, 6, v3
    s_waitcnt lgkmcnt(0)
    v_mfma_f32_32x32x16_bf16 v[96:111], v[32:35], v[48:51], 0
    v_mfma_f32_32x32x16_bf16 v[96:111], v[36:39], v[52:55], v[96:111]
    v_mfma_f32_32x32x16_bf16 v[96:111], v[40:43], v[56:59], v[96:111]
    v_mfma_f32_32x32x16_bf16 v[96:111], v[44:47], v[60:63], v[96:111]
    s_cmp_eq_u32 s86, 1
    s_cbranch_scc1 L2_xu
    v_lshlrev_b32 v2, 2, v2
    v_mov_b32 v3, 0xbfb8aa3b
    s_nop 8
    v_fmaak_f32 v96, v3, v96, 0xc1f80000
    ds_write_b32 v2, v96 offset:0
    v_fmaak_f32 v97, v3, v97, 0xc1f80000
    ds_write_b32 v2, v97 offset:256
    v_fmaak_f32 v98, v3, v98, 0xc1f80000
    ds_write_b32 v2, v98 offset:512
    v_fmaak_f32 v99, v3, v99, 0xc1f80000
    ds_write_b32 v2, v99 offset:768
    v_fmaak_f32 v100, v3, v100, 0xc1f80000
    ds_write_b32 v2, v100 offset:2048
    v_fmaak_f32 v101, v3, v101, 0xc1f80000
    ds_write_b32 v2, v101 offset:2304
    v_fmaak_f32 v102, v3, v102, 0xc1f80000
    ds_write_b32 v2, v102 offset:2560
    v_fmaak_f32 v103, v3, v103, 0xc1f80000
    ds_write_b32 v2, v103 offset:2816
    s_cmp_eq_u32 s91, 1
    s_cselect_b32 exec_hi, 0, -1
    v_fmaak_f32 v104, v3, v104, 0xc1f80000
    ds_write_b32 v2, v104 offset:4096
    v_fmaak_f32 v105, v3, v105, 0xc1f80000
    ds_write_b32 v2, v105 offset:4352
    s_mov_b64 exec, -1
    s_cbranch_scc1 L2_pdone
    v_fmaak_f32 v106, v3, v106, 0xc1f80000
    ds_write_b32 v2, v106 offset:4608
    v_fmaak_f32 v107, v3, v107, 0xc1f80000
    ds_write_b32 v2, v107 offset:4864
    v_fmaak_f32 v108, v3, v108, 0xc1f80000
    ds_write_b32 v2, v108 offset:6144
    v_fmaak_f32 v109, v3, v109, 0xc1f80000
    ds_write_b32 v2, v109 offset:6400
    v_fmaak_f32 v110, v3, v110, 0xc1f80000
    ds_write_b32 v2, v110 offset:6656
    v_fmaak_f32 v111, v3, v111, 0xc1f80000
    ds_write_b32 v2, v111 offset:6912
    s_branch L2_pdone
L2_xu:
    v_lshlrev_b32 v2, 3, v2
    s_nop 9
    v_cvt_f64_f32 v[32:33], v96
    ds_write_b64 v2, v[32:33] offset:13312
    v_cvt_f64_f32 v[34:35], v97
    ds_write_b64 v2, v[34:35] offset:13824
    v_cvt_f64_f32 v[36:37], v98
    ds_write_b64 v2, v[36:37] offset:14336
    v_cvt_f64_f32 v[38:39], v99
    ds_write_b64 v2, v[38:39] offset:14848
    v_cvt_f64_f32 v[40:41], v100
    ds_write_b64 v2, v[40:41] offset:17408
    v_cvt_f64_f32 v[42:43], v101
    ds_write_b64 v2, v[42:43] offset:17920
    v_cvt_f64_f32 v[44:45], v102
    ds_write_b64 v2, v[44:45] offset:18432
    v_cvt_f64_f32 v[46:47], v103
    ds_write_b64 v2, v[46:47] offset:18944
    s_cmp_eq_u32 s91, 1
    s_cselect_b32 exec_hi, 0, -1
    v_cvt_f64_f32 v[32:33], v104
    ds_write_b64 v2, v[32:33] offset:21504
    v_cvt_f64_f32 v[34:35], v105
    ds_write_b64 v2, v[34:35] offset:22016
    s_mov_b64 exec, -1
    s_cbranch_scc1 L2_pdone
    v_cvt_f64_f32 v[36:37], v106
    ds_write_b64 v2, v[36:37] offset:22528
    v_cvt_f64_f32 v[38:39], v107
    ds_write_b64 v2, v[38:39] offset:23040
    v_cvt_f64_f32 v[40:41], v108
    ds_write_b64 v2, v[40:41] offset:25600
    v_cvt_f64_f32 v[42:43], v109
    ds_write_b64 v2, v[42:43] offset:26112
    v_cvt_f64_f32 v[44:45], v110
    ds_write_b64 v2, v[44:45] offset:26624
    v_cvt_f64_f32 v[46:47], v111
    ds_write_b64 v2, v[46:47] offset:27136
L2_pdone:
    v_lshrrev_b32 v2, 4, v10
    v_and_b32 v3, 15, v10
    v_and_b32 v4, 3, v3
    s_lshr_b32 s27, s3, 3
    s_lshl_b32 s27, s27, 7
    s_and_b32 s81, s3, 7
    s_add_u32 s27, s27, s81
    v_lshl_add_u32 v2, v2, 5, s27
    v_lshl_add_u32 v4, v4, 3, v2
    v_lshlrev_b32 v4, 11, v4
    s_mov_b32 s81, 37536
    v_mul_lo_u32 v8, v2, s81
    v_mad_u32_u24 v8, v3, 12, v8
    s_mov_b32 s64, 0
    s_mov_b32 s65, 300288
    s_mov_b32 s66, 600576
    s_mov_b32 s67, 900864
    s_lshl_b32 s72, s30, 3
    s_add_u32 s72, s72, 10485760
    s_mul_i32 s82, s31, 100000
    s_add_u32 s82, s82, 12582912
    s_mov_b32 s21, 0
    v_mov_b32 v50, 0x30000000
    v_mov_b32 v51, 0x30000000
    s_mov_b32 s87, 50000
    v_and_b32 v3, 1, v10
    v_bfe_u32 v5, v10, 1, 2
    v_lshl_or_b32 v3, v3, 2, v5
    v_and_b32 v5, 56, v10
    v_or_b32 v60, v3, v5
    v_lshrrev_b32 v3, 2, v60
    v_lshlrev_b32 v14, v3, 2
    v_subrev_u32 v14, 1, v14
    s_cmp_lg_u32 s3, 15
    s_cbranch_scc1 L2_nd
    v_lshlrev_b32 v1, 4, v10
    v_add_u32 v2, 151552, v1
    ds_read_b128 v[64:67], v2
    v_lshlrev_b32 v1, 1, v1
    s_lshl_b32 s85, s2, 11
    s_add_u32 s85, s85, 10485760
L2_nd:
    s_waitcnt vmcnt(0) lgkmcnt(0)
    v_lshlrev_b32 v76, 16, v76
    v_lshlrev_b32 v77, 16, v77
    v_lshlrev_b32 v78, 16, v78
    v_lshlrev_b32 v79, 16, v79
    v_mul_f32 v76, 0xbfb8aa3b, v76
    v_mul_f32 v77, 0xbfb8aa3b, v77
    v_mul_f32 v78, 0xbfb8aa3b, v78
    v_mul_f32 v79, 0xbfb8aa3b, v79
    v_cvt_pk_bf16_f32 v28, v76, v77
    v_cvt_pk_bf16_f32 v29, v78, v79
L2_tag:
    v_readfirstlane_b32 s74, v72
    v_readfirstlane_b32 s75, v73
    s_sub_u32 s87, s87, 1
    s_cmp_lg_u32 s75, 0
    s_cbranch_scc1 L2_tagok
    s_cmp_le_i32 s87, 0
    s_cbranch_scc1 L2_tagno
    buffer_load_dwordx2 v[72:73], v74, s[68:71], 0 offen sc1
    s_waitcnt vmcnt(0)
    s_branch L2_tag
L2_tagok:
    v_mov_b32 v81, s75
    v_mov_b32 v83, s75
    v_mov_b32 v85, s75
    v_mov_b32 v87, s75
    v_or_b32 v80, s74, v64
    v_or_b32 v82, s74, v65
    v_or_b32 v84, s74, v66
    v_or_b32 v86, s74, v67
    s_barrier
    s_cmp_lg_u32 s3, 15
    s_cbranch_scc1 L2_wf
    s_add_u32 s82, s82, 16384
    buffer_store_dwordx4 v[80:83], v1, s[12:15], s85 offen sc1
    buffer_store_dwordx4 v[84:87], v1, s[12:15], s85 offen offset:16 sc1
    s_waitcnt vmcnt(0)
L2_f:
    s_barrier
    s_cmp_lg_u32 s3, 0
    s_cbranch_scc1 L2_nn
    v_mov_b32 v1, 25088
    v_mov_b32 v5, 50176
    v_mov_b32 v6, 3200000
    v_mov_b32 v2, 0
    v_mov_b32 v3, 0
    ds_write_b32 v1, v6 offset:38912
    ds_write_b64 v5, v[2:3] offset:64512
L2_nn:
L2_poll:
    buffer_load_dwordx2 v[2:3], v4, s[12:15], s72 offen sc1
    s_sub_u32 s87, s87, 1
    s_waitcnt vmcnt(0)
L2_pc:
    v_xor_b32 v2, s74, v2
    v_cmp_ne_u32 vcc, s75, v3
    v_lshrrev_b32 v3, 24, v2
    v_cmp_ne_u32 s[84:85], 0, v3
    s_or_b64 vcc, vcc, s[84:85]
    s_cbranch_scc0 L2_g
    s_cmp_le_i32 s87, 0
    s_cbranch_scc1 L2_gno
    s_sleep 2
    s_branch L2_poll
L2_g:
    v_and_b32 v3, 0xfff, v2
    v_bfe_u32 v2, v2, 12, 12
    v_mul_u32_u24 v3, 12, v3
    v_lshl_or_b32 v9, v2, 16, v3
L2_pass:
    v_and_b32 v3, 15, v10
    v_add_u32 v1, s21, v3
    v_add_u32 v2, 16, v1
    s_add_u32 s83, s21, 32
    v_lshrrev_b32 v4, 16, v9
    v_cmp_lt_u32 vcc, s83, v4
    s_cmp_lg_u64 vcc, 0
    s_cselect_b32 s25, 1, 0
    v_mov_b32_dpp v104, v4 row_newbcast:0 row_mask:0xf bank_mask:0xf
    v_cmp_lt_u32 s[32:33], v1, v104
    v_cmp_lt_u32 s[40:41], v2, v104
    v_mov_b32_dpp v104, v4 row_newbcast:1 row_mask:0xf bank_mask:0xf
    v_cmp_lt_u32 s[34:35], v1, v104
    v_cmp_lt_u32 s[42:43], v2, v104
    v_mov_b32_dpp v104, v4 row_newbcast:2 row_mask:0xf bank_mask:0xf
    v_cmp_lt_u32 s[36:37], v1, v104
    v_cmp_lt_u32 s[44:45], v2, v104
    v_mov_b32_dpp v104, v4 row_newbcast:3 row_mask:0xf bank_mask:0xf
    v_cmp_lt_u32 s[38:39], v1, v104
    v_cmp_lt_u32 s[46:47], v2, v104
L2_again:
    s_mul_i32 s84, s21, 12
    v_add_u32 v6, s84, v8
    v_and_b32 v5, 0xffff, v9
    s_nop 1
    v_add_u32_dpp v105, v5, v6 row_newbcast:0 row_mask:0xf bank_mask:0xf
    v_add_u32_dpp v106, v5, v6 row_newbcast:1 row_mask:0xf bank_mask:0xf
    v_add_u32_dpp v107, v5, v6 row_newbcast:2 row_mask:0xf bank_mask:0xf
    v_add_u32_dpp v108, v5, v6 row_newbcast:3 row_mask:0xf bank_mask:0xf
    s_mov_b64 exec, s[40:41]
    s_cbranch_execz L2_r2_0
    buffer_load_dwordx3 v[80:82], v105, s[12:15], s64 offen offset:192 sc1
L2_r2_0:
    s_mov_b64 exec, s[42:43]
    s_cbranch_execz L2_r2_1
    buffer_load_dwordx3 v[84:86], v106, s[12:15], s65 offen offset:192 sc1
L2_r2_1:
    s_mov_b64 exec, s[44:45]
    s_cbranch_execz L2_r2_2
    buffer_load_dwordx3 v[88:90], v107, s[12:15], s66 offen offset:192 sc1
L2_r2_2:
    s_mov_b64 exec, s[46:47]
    s_cbranch_execz L2_r2_3
    buffer_load_dwordx3 v[92:94], v108, s[12:15], s67 offen offset:192 sc1
L2_r2_3:
    s_mov_b64 exec, s[32:33]
    buffer_load_dwordx3 v[64:66], v105, s[12:15], s64 offen sc1
    s_mov_b64 exec, s[34:35]
    buffer_load_dwordx3 v[68:70], v106, s[12:15], s65 offen sc1
    s_mov_b64 exec, s[36:37]
    buffer_load_dwordx3 v[72:74], v107, s[12:15], s66 offen sc1
    s_mov_b64 exec, s[38:39]
    buffer_load_dwordx3 v[76:78], v108, s[12:15], s67 offen sc1
    s_mov_b64 exec, -1
    v_mov_b32 v1, 4
    v_mov_b32 v2, 151040
    s_cmp_eq_u32 s25, 0
    s_cbranch_scc1 L2_nomore
    ds_write_b32 v2, v1 offset:256
L2_nomore:
    v_cmp_gt_u32 s[92:93], 49, v10
    v_mov_b32 v6, 16
    v_mov_b32 v5, 512
    v_cndmask_b32 v6, 0, v6, s[92:93]
    s_waitcnt vmcnt(3)
    s_mov_b64 exec, s[32:33]
    v_add_u32_sdwa v96, v66, v2 dst_sel:DWORD dst_unused:UNUSED_PAD src0_sel:BYTE_3 src1_sel:DWORD
    ds_add_rtn_u32 v67, v96, v1
    v_lshrrev_b32 v96, 26, v66
    v_and_b32 v66, 0xffffff, v66
    s_waitcnt vmcnt(2)
    s_mov_b64 exec, s[34:35]
    v_add_u32_sdwa v97, v70, v2 dst_sel:DWORD dst_unused:UNUSED_PAD src0_sel:BYTE_3 src1_sel:DWORD
    ds_add_rtn_u32 v71, v97, v1
    v_lshrrev_b32 v97, 26, v70
    v_and_b32 v70, 0xffffff, v70
    s_waitcnt vmcnt(1)
    s_mov_b64 exec, s[36:37]
    v_add_u32_sdwa v98, v74, v2 dst_sel:DWORD dst_unused:UNUSED_PAD src0_sel:BYTE_3 src1_sel:DWORD
    ds_add_rtn_u32 v75, v98, v1
    v_lshrrev_b32 v98, 26, v74
    v_and_b32 v74, 0xffffff, v74
    s_waitcnt vmcnt(0)
    s_mov_b64 exec, s[38:39]
    v_add_u32_sdwa v99, v78, v2 dst_sel:DWORD dst_unused:UNUSED_PAD src0_sel:BYTE_3 src1_sel:DWORD
    ds_add_rtn_u32 v79, v99, v1
    v_lshrrev_b32 v99, 26, v78
    v_and_b32 v78, 0xffffff, v78
    s_mov_b64 exec, s[40:41]
    s_cbranch_execz L2_rk4
    v_add_u32_sdwa v100, v82, v2 dst_sel:DWORD dst_unused:UNUSED_PAD src0_sel:BYTE_3 src1_sel:DWORD
    ds_add_rtn_u32 v83, v100, v1
    v_lshrrev_b32 v100, 26, v82
    v_and_b32 v82, 0xffffff, v82
L2_rk4:
    s_mov_b64 exec, s[42:43]
    s_cbranch_execz L2_rk5
    v_add_u32_sdwa v101, v86, v2 dst_sel:DWORD dst_unused:UNUSED_PAD src0_sel:BYTE_3 src1_sel:DWORD
    ds_add_rtn_u32 v87, v101, v1
    v_lshrrev_b32 v101, 26, v86
    v_and_b32 v86, 0xffffff, v86
L2_rk5:
    s_mov_b64 exec, s[44:45]
    s_cbranch_execz L2_rk6
    v_add_u32_sdwa v102, v90, v2 dst_sel:DWORD dst_unused:UNUSED_PAD src0_sel:BYTE_3 src1_sel:DWORD
    ds_add_rtn_u32 v91, v102, v1
    v_lshrrev_b32 v102, 26, v90
    v_and_b32 v90, 0xffffff, v90
L2_rk6:
    s_mov_b64 exec, s[46:47]
    s_cbranch_execz L2_rk7
    v_add_u32_sdwa v103, v94, v2 dst_sel:DWORD dst_unused:UNUSED_PAD src0_sel:BYTE_3 src1_sel:DWORD
    ds_add_rtn_u32 v95, v103, v1
    v_lshrrev_b32 v103, 26, v94
    v_and_b32 v94, 0xffffff, v94
L2_rk7:
    s_waitcnt lgkmcnt(0)
    s_mov_b64 exec, s[32:33]
    v_lshl_add_u32 v96, v96, 9, v67
    v_cmpx_lt_u32 vcc, v67, v5
    v_add_u32 v104, v96, v96
    ds_write_b32 v96, v66 offset:38912
    ds_write_b64 v104, v[64:65] offset:64512
    s_mov_b64 exec, s[34:35]
    v_lshl_add_u32 v97, v97, 9, v71
    v_cmpx_lt_u32 vcc, v71, v5
    v_add_u32 v105, v97, v97
    ds_write_b32 v97, v70 offset:38912
    ds_write_b64 v105, v[68:69] offset:64512
    s_mov_b64 exec, s[36:37]
    v_lshl_add_u32 v98, v98, 9, v75
    v_cmpx_lt_u32 vcc, v75, v5
    v_add_u32 v106, v98, v98
    ds_write_b32 v98, v74 offset:38912
    ds_write_b64 v106, v[72:73] offset:64512
    s_mov_b64 exec, s[38:39]
    v_lshl_add_u32 v99, v99, 9, v79
    v_cmpx_lt_u32 vcc, v79, v5
    v_add_u32 v107, v99, v99
    ds_write_b32 v99, v78 offset:38912
    ds_write_b64 v107, v[76:77] offset:64512
    s_mov_b64 exec, s[40:41]
    s_cbranch_execz L2_sc4
    v_lshl_add_u32 v100, v100, 9, v83
    v_cmpx_lt_u32 vcc, v83, v5
    v_add_u32 v108, v100, v100
    ds_write_b32 v100, v82 offset:38912
    ds_write_b64 v108, v[80:81] offset:64512
L2_sc4:
    s_mov_b64 exec, s[42:43]
    s_cbranch_execz L2_sc5
    v_lshl_add_u32 v101, v101, 9, v87
    v_cmpx_lt_u32 vcc, v87, v5
    v_add_u32 v109, v101, v101
    ds_write_b32 v101, v86 offset:38912
    ds_write_b64 v109, v[84:85] offset:64512
L2_sc5:
    s_mov_b64 exec, s[44:45]
    s_cbranch_execz L2_sc6
    v_lshl_add_u32 v102, v102, 9, v91
    v_cmpx_lt_u32 vcc, v91, v5
    v_add_u32 v110, v102, v102
    ds_write_b32 v102, v90 offset:38912
    ds_write_b64 v110, v[88:89] offset:64512
L2_sc6:
    s_mov_b64 exec, s[46:47]
    s_cbranch_execz L2_sc7
    v_lshl_add_u32 v103, v103, 9, v95
    v_cmpx_lt_u32 vcc, v95, v5
    v_add_u32 v111, v103, v103
    ds_write_b32 v103, v94 offset:38912
    ds_write_b64 v111, v[92:93] offset:64512
L2_sc7:
    s_mov_b64 exec, -1
    v_lshl_add_u32 v1, v10, 2, v2
    s_bitcmp1_b32 s3, 0
    s_cbranch_scc1 L2_nwq
    s_lshr_b32 s84, s3, 1
    s_mul_i32 s84, s84, 1024
    s_add_u32 s84, s84, s82
    s_add_u32 s84, s84, 16384
    v_lshlrev_b32 v116, 4, v10
    buffer_load_dwordx4 v[112:115], v116, s[12:15], s84 offen sc1
    s_add_u32 s84, s84, 1024
L2_nwq:
    s_waitcnt lgkmcnt(0)
    s_setprio 3
    s_barrier
    ds_read_b32 v3, v1
    ds_read2_b32 v[4:5], v2 offset0:64 offset1:70
    s_mov_b32 s84, s82
    buffer_load_dwordx4 v[112:115], v7, s[12:15], s84 offen sc1
    s_add_u32 s84, s84, 16384
    s_movk_i32 s84, 512
    s_waitcnt lgkmcnt(0)
    v_readfirstlane_b32 s25, v4
    v_readfirstlane_b32 s85, v5
    s_cmp_lg_u32 s85, 0
    s_cbranch_scc1 L9_alone
L2_cap:
    v_cmp_lt_u32 vcc, s84, v3
    v_min_u32 v4, s84, v3
    v_add_u32 v5, 15, v4
    v_and_b32 v5, -16, v5
    v_max_u32 v5, v5, v6
    v_mov_b32 v104, v5
    s_cmp_lg_u64 vcc, 0
    s_cselect_b32 s20, 1, 0
    v_add_u32_dpp v104, v104, v104 row_shr:1 row_mask:0xf bank_mask:0xf bound_ctrl:0
    s_nop 1
    v_add_u32_dpp v104, v104, v104 row_shr:2 row_mask:0xf bank_mask:0xf bound_ctrl:0
    s_nop 1
    v_add_u32_dpp v104, v104, v104 row_shr:4 row_mask:0xf bank_mask:0xf bound_ctrl:0
    s_nop 1
    v_add_u32_dpp v104, v104, v104 row_shr:8 row_mask:0xf bank_mask:0xf bound_ctrl:0
    s_nop 1
    v_add_u32_dpp v104, v104, v104 row_bcast:15 row_mask:0xa bank_mask:0xf
    s_nop 1
    v_add_u32_dpp v104, v104, v104 row_bcast:31 row_mask:0xc bank_mask:0xf
    s_nop 0
    v_readlane_b32 s26, v104, 63
    v_sub_u32 v5, v104, v5
    s_cmp_gt_u32 s26, 15360
    s_cbranch_scc1 L2_over
    s_cmp_lg_u32 s20, 0
    s_cbranch_scc1 L2_pend
L2_pendb:
    v_lshl_or_b32 v4, v4, 16, v5
    s_add_u32 s86, s26, 63
    s_lshr_b32 s86, s86, 6
    s_lshr_b32 s22, s86, 4
    s_and_b32 s88, s86, 15
    s_mul_i32 s87, s22, s3
    s_min_u32 s89, s3, s88
    s_add_u32 s87, s87, s89
    s_cmp_lt_u32 s3, s88
    s_addc_u32 s22, s22, 0
    s_add_u32 s88, s87, s22
    s_lshl_b32 s89, s87, 6
    s_lshl_b32 s90, s88, 6
    v_cmp_ge_u32 vcc, s89, v5
    s_and_b64 s[94:95], vcc, s[92:93]
    s_bcnt1_i32_b64 s91, s[94:95]
    s_sub_u32 s91, s91, 1
    v_cmp_gt_u32 vcc, s90, v5
    s_andn2_b64 s[94:95], vcc, s[94:95]
    s_and_b64 s[94:95], s[94:95], s[92:93]
    s_lshl_b32 s96, s91, 8
    v_lshl_add_u32 v13, v10, 2, s96
    ds_read_b32 v20, v13 offset:0
    ds_read_b32 v48, v13 offset:256
    v_subrev_u32 v5, s89, v5
    v_lshrrev_b32 v5, 2, v5
    v_cndmask_b32 v5, 0, v5, s[94:95]
    v_mov_b32 v3, 1
    ds_permute_b32 v76, v5, v3
    s_waitcnt lgkmcnt(0)
    v_cmp_ne_u32 s[76:77], 0, v76
    s_and_b32 s76, s76, -2
    s_mov_b64 s[84:85], s[76:77]
    s_mov_b32 s86, s91
    v_and_b32 v64, s84, v14
    v_bcnt_u32_b32 v64, v64, 0
    v_add_lshl_u32 v64, v64, s86, 2
    ds_bpermute_b32 v68, v64, v4
    s_and_b32 s87, s84, 0xffff
    s_bcnt1_i32_b32 s87, s87
    s_add_u32 s86, s86, s87
    s_lshr_b64 s[84:85], s[84:85], 16
    v_and_b32 v65, s84, v14
    v_bcnt_u32_b32 v65, v65, 0
    v_add_lshl_u32 v65, v65, s86, 2
    ds_bpermute_b32 v69, v65, v4
    s_and_b32 s87, s84, 0xffff
    s_bcnt1_i32_b32 s87, s87
    s_add_u32 s86, s86, s87
    s_lshr_b64 s[84:85], s[84:85], 16
    v_and_b32 v66, s84, v14
    v_bcnt_u32_b32 v66, v66, 0
    v_add_lshl_u32 v66, v66, s86, 2
    ds_bpermute_b32 v70, v66, v4
    s_and_b32 s87, s84, 0xffff
    s_bcnt1_i32_b32 s87, s87
    s_add_u32 s86, s86, s87
    s_lshr_b64 s[84:85], s[84:85], 16
    v_and_b32 v67, s84, v14
    v_bcnt_u32_b32 v67, v67, 0
    v_add_lshl_u32 v67, v67, s86, 2
    ds_bpermute_b32 v71, v67, v4
    v_lshl_add_u32 v3, v60, 2, s89
    v_mov_b32 v5, 25088
    s_lshl_b32 s96, s3, 10
    s_add_u32 s96, s96, 115712
    v_mov_b32 v15, s96
    v_lshl_add_u32 v6, v10, 2, s96
    s_waitcnt lgkmcnt(3)
    v_sub_u32_sdwa v72, v3, v68 dst_sel:DWORD dst_unused:UNUSED_PAD src0_sel:DWORD src1_sel:WORD_0
    v_lshrrev_b32 v68, 16, v68
    v_cmp_lt_u32 vcc, v72, v68
    v_lshl_add_u32 v72, v64, 7, v72
    v_add_u32 v3, 0x100, v3
    v_cndmask_b32 v72, v5, v72, vcc
    ds_read_b32 v64, v72 offset:38912
    v_add_u32 v72, v72, v72
    ds_read_b64 v[30:31], v72 offset:64512
    s_waitcnt lgkmcnt(4)
    v_sub_u32_sdwa v73, v3, v69 dst_sel:DWORD dst_unused:UNUSED_PAD src0_sel:DWORD src1_sel:WORD_0
    v_lshrrev_b32 v69, 16, v69
    v_cmp_lt_u32 vcc, v73, v69
    v_lshl_add_u32 v73, v65, 7, v73
    v_add_u32 v3, 0x100, v3
    v_cndmask_b32 v73, v5, v73, vcc
    ds_read_b32 v65, v73 offset:38912
    v_add_u32 v73, v73, v73
    ds_read_b64 v[54:55], v73 offset:64512
    s_waitcnt lgkmcnt(5)
    v_sub_u32_sdwa v74, v3, v70 dst_sel:DWORD dst_unused:UNUSED_PAD src0_sel:DWORD src1_sel:WORD_0
    v_lshrrev_b32 v70, 16, v70
    v_cmp_lt_u32 vcc, v74, v70
    v_lshl_add_u32 v74, v66, 7, v74
    v_add_u32 v3, 0x100, v3
    v_cndmask_b32 v74, v5, v74, vcc
    ds_read_b32 v66, v74 offset:38912
    v_add_u32 v74, v74, v74
    ds_read_b64 v[56:57], v74 offset:64512
    s_waitcnt lgkmcnt(6)
    v_sub_u32_sdwa v75, v3, v71 dst_sel:DWORD dst_unused:UNUSED_PAD src0_sel:DWORD src1_sel:WORD_0
    v_lshrrev_b32 v71, 16, v71
    v_cmp_lt_u32 vcc, v75, v71
    v_lshl_add_u32 v75, v67, 7, v75
    s_nop 0
    v_cndmask_b32 v75, v5, v75, vcc
    ds_read_b32 v67, v75 offset:38912
    v_add_u32 v75, v75, v75
    ds_read_b64 v[58:59], v75 offset:64512
    s_lshr_b64 s[84:85], s[76:77], 1
    s_or_b64 s[84:85], s[84:85], s[76:77]
    s_lshr_b64 s[86:87], s[84:85], 2
    s_or_b64 s[84:85], s[84:85], s[86:87]
    s_mov_b32 s86, 0x11111111
    s_mov_b32 s87, 0x11111111
    s_and_b64 s[84:85], s[84:85], s[86:87]
    s_waitcnt lgkmcnt(7)
    ds_write_b32 v6, v64 offset:0
    s_waitcnt lgkmcnt(6)
    ds_write_b32 v6, v65 offset:256
    s_waitcnt lgkmcnt(5)
    ds_write_b32 v6, v66 offset:512
    s_waitcnt lgkmcnt(4)
    ds_write_b32 v6, v67 offset:768
    ds_read_b128 v[64:67], v15 offset:0
    ds_read_b128 v[68:71], v15 offset:16
    ds_read_b128 v[72:75], v15 offset:32
    ds_read_b128 v[76:79], v15 offset:48
    s_lshl_b64 s[28:29], s[84:85], 5
    s_or_b64 s[28:29], s[28:29], s[84:85]
    s_lshl_b64 s[4:5], s[76:77], 4
    s_lshl_b32 s88, s22, 2
    s_max_u32 s90, s88, 4
    s_sub_u32 s90, s90, 4
    s_lshr_b64 s[84:85], s[76:77], s90
    s_and_b32 s23, s84, 15
    s_cmp_eq_u32 s22, 0
    s_cbranch_scc1 L2_done
    s_waitcnt lgkmcnt(0)
    buffer_load_dword v64, v64, s[8:11], 0 offen
    buffer_load_dword v65, v65, s[8:11], 0 offen
    buffer_load_dword v66, v66, s[8:11], 0 offen
    buffer_load_dword v67, v67, s[8:11], 0 offen
    buffer_load_dword v68, v68, s[8:11], 0 offen
    buffer_load_dword v69, v69, s[8:11], 0 offen
    buffer_load_dword v70, v70, s[8:11], 0 offen
    buffer_load_dword v71, v71, s[8:11], 0 offen
    buffer_load_dword v72, v72, s[8:11], 0 offen
    buffer_load_dword v73, v73, s[8:11], 0 offen
    buffer_load_dword v74, v74, s[8:11], 0 offen
    buffer_load_dword v75, v75, s[8:11], 0 offen
    buffer_load_dword v76, v76, s[8:11], 0 offen
    buffer_load_dword v77, v77, s[8:11], 0 offen
    buffer_load_dword v78, v78, s[8:11], 0 offen
    buffer_load_dword v79, v79, s[8:11], 0 offen
    ds_read_b128 v[80:83], v15 offset:64
    ds_read_b128 v[84:87], v15 offset:80
    ds_read_b128 v[88:91], v15 offset:96
    ds_read_b128 v[92:95], v15 offset:112
    s_mov_b32 s84, 0x55555555
    s_mov_b32 s85, 0x55555555
    s_lshl_b64 s[84:85], s[84:85], s90
    s_or_b64 s[28:29], s[28:29], s[84:85]
    s_mov_b64 s[84:85], 8
    s_lshl_b64 s[84:85], s[84:85], s88
    s_or_b64 s[28:29], s[28:29], s[84:85]
    s_mov_b32 s6, 0
    s_mov_b32 s7, 3
    s_cmp_gt_u32 s22, 6
    s_cbranch_scc0 L3_np0
    s_sub_u32 s90, s22, 6
    s_bitset1_b32 s6, s90
    s_lshl_b32 s90, s90, 2
    s_bitset1_b64 s[28:29], s90
L3_np0:
    s_cmp_gt_u32 s22, 3
    s_cbranch_scc0 L3_np1
    s_sub_u32 s90, s22, 3
    s_bitset1_b32 s6, s90
    s_lshl_b32 s90, s90, 2
    s_bitset1_b64 s[28:29], s90
L3_np1:
    s_cmp_gt_u32 s22, 1
    s_cbranch_scc0 L3_np2
    s_sub_u32 s90, s22, 1
    s_bitset1_b32 s6, s90
    s_lshl_b32 s90, s90, 2
    s_bitset1_b64 s[28:29], s90
L3_np2:
    v_add_u32 v12, v13, v13
    v_add_u32 v13, 0x100, v13
    v_mov_b32 v18, 0
    v_mov_b32 v19, 0
    v_mov_b32 v21, v20
    v_mov_b32 v22, v20
    v_mov_b32 v23, v20
    s_waitcnt vmcnt(16) lgkmcnt(0)
    v_mov_b32 v112, 0
    v_mov_b32 v114, 1.0
    v_mov_b32 v113, 0
    v_mov_b32 v115, 1.0
    v_mov_b32 v120, 0
    v_mov_b32 v122, 1.0
    v_mov_b32 v121, 0
    v_mov_b32 v123, 1.0
    .p2align 3
L2_loop:
    s_bitcmp1_b32 s28, 0
    s_cbranch_scc1 L3_se0
    s_waitcnt vmcnt(0) lgkmcnt(0)
    v_mfma_f32_4x4x4_16b_bf16 v[32:35], v[30:31], v[28:29], v[20:23] cbsz:4 abid:0
    v_rcp_f32 v114, v114
    v_mfma_f32_4x4x4_16b_bf16 v[36:39], v[30:31], v[28:29], v[20:23] cbsz:4 abid:1
    v_rcp_f32 v115, v115
    v_mfma_f32_4x4x4_16b_bf16 v[32:35], v[26:27], v[64:65], v[32:35]
    v_rcp_f32 v122, v122
    v_mfma_f32_4x4x4_16b_bf16 v[40:43], v[30:31], v[28:29], v[20:23] cbsz:4 abid:2
    v_rcp_f32 v123, v123
    v_mfma_f32_4x4x4_16b_bf16 v[32:35], v[24:25], v[66:67], v[32:35]
    v_mfma_f32_4x4x4_16b_bf16 v[44:47], v[30:31], v[28:29], v[20:23] cbsz:4 abid:3
    v_mfma_f32_4x4x4_16b_bf16 v[36:39], v[26:27], v[68:69], v[36:39]
    v_mfma_f32_4x4x4_16b_bf16 v[40:43], v[26:27], v[72:73], v[40:43]
    s_bitcmp1_b32 s28, 1
    v_mfma_f32_4x4x4_16b_bf16 v[36:39], v[24:25], v[70:71], v[36:39]
    v_exp_f32_e64 v32, v32 clamp
    buffer_load_dword v80, v80, s[8:11], 0 offen
    v_mfma_f32_4x4x4_16b_bf16 v[44:47], v[26:27], v[76:77], v[44:47]
    v_exp_f32_e64 v33, v33 clamp
    buffer_load_dword v81, v81, s[8:11], 0 offen
    v_mfma_f32_4x4x4_16b_bf16 v[40:43], v[24:25], v[74:75], v[40:43]
    v_exp_f32_e64 v34, v34 clamp
    buffer_load_dword v82, v82, s[8:11], 0 offen
    v_mfma_f32_4x4x4_16b_bf16 v[44:47], v[24:25], v[78:79], v[44:47]
    v_exp_f32_e64 v35, v35 clamp
    buffer_load_dword v83, v83, s[8:11], 0 offen
    v_exp_f32_e64 v36, v36 clamp
    buffer_load_dword v84, v84, s[8:11], 0 offen
    v_exp_f32_e64 v37, v37 clamp
    buffer_load_dword v85, v85, s[8:11], 0 offen
    v_exp_f32_e64 v38, v38 clamp
    buffer_load_dword v86, v86, s[8:11], 0 offen
    v_exp_f32_e64 v39, v39 clamp
    buffer_load_dword v87, v87, s[8:11], 0 offen
    v_exp_f32_e64 v40, v40 clamp
    buffer_load_dword v88, v88, s[8:11], 0 offen
    v_exp_f32_e64 v41, v41 clamp
    buffer_load_dword v89, v89, s[8:11], 0 offen
    v_exp_f32_e64 v42, v42 clamp
    buffer_load_dword v90, v90, s[8:11], 0 offen
    v_exp_f32_e64 v43, v43 clamp
    buffer_load_dword v91, v91, s[8:11], 0 offen
    v_exp_f32_e64 v44, v44 clamp
    buffer_load_dword v92, v92, s[8:11], 0 offen
    v_exp_f32_e64 v45, v45 clamp
    buffer_load_dword v93, v93, s[8:11], 0 offen
    v_exp_f32_e64 v46, v46 clamp
    buffer_load_dword v94, v94, s[8:11], 0 offen
    v_exp_f32_e64 v47, v47 clamp
    buffer_load_dword v95, v95, s[8:11], 0 offen
L3_xb0:
    s_cbranch_scc1 L3_sf0
    v_pk_fma_f32 v[18:19], v[112:113], v[114:115], v[18:19]
    v_pk_fma_f32 v[18:19], v[120:121], v[122:123], v[18:19]
L3_fb0:
    ds_read_b128 v[96:99], v15 offset:128
    ds_read_b128 v[100:103], v15 offset:144
    ds_read_b128 v[104:107], v15 offset:160
    ds_read_b128 v[108:111], v15 offset:176
    v_pk_add_f32 v[32:33], v[32:33], v[50:51]
    v_pk_add_f32 v[34:35], v[34:35], v[50:51]
    v_pk_add_f32 v[36:37], v[36:37], v[50:51]
    v_pk_add_f32 v[38:39], v[38:39], v[50:51]
    v_pk_add_f32 v[40:41], v[40:41], v[50:51]
    v_pk_add_f32 v[42:43], v[42:43], v[50:51]
    v_pk_add_f32 v[44:45], v[44:45], v[50:51]
    v_pk_add_f32 v[46:47], v[46:47], v[50:51]
    v_pk_mul_f32 v[64:65], v[64:65], v[34:35]
    v_pk_mul_f32 v[72:73], v[72:73], v[42:43]
    v_pk_mul_f32 v[68:69], v[68:69], v[38:39]
    v_pk_mul_f32 v[76:77], v[76:77], v[46:47]
    v_pk_fma_f32 v[64:65], v[66:67], v[32:33], v[64:65]
    v_pk_fma_f32 v[72:73], v[74:75], v[40:41], v[72:73]
    v_pk_fma_f32 v[68:69], v[70:71], v[36:37], v[68:69]
    v_pk_fma_f32 v[76:77], v[78:79], v[44:45], v[76:77]
    v_pk_mul_f32 v[32:33], v[32:33], v[34:35]
    v_pk_mul_f32 v[40:41], v[40:41], v[42:43]
    v_pk_mul_f32 v[36:37], v[36:37], v[38:39]
    v_pk_mul_f32 v[44:45], v[44:45], v[46:47]
    v_pk_mul_f32 v[64:65], v[64:65], v[36:37]
    v_pk_mul_f32 v[72:73], v[72:73], v[44:45]
    v_pk_mul_f32 v[66:67], v[32:33], v[36:37]
    v_pk_mul_f32 v[74:75], v[40:41], v[44:45]
    v_pk_fma_f32 v[64:65], v[68:69], v[32:33], v[64:65]
    v_pk_fma_f32 v[72:73], v[76:77], v[40:41], v[72:73]
    s_bitcmp1_b32 s28, 4
    s_cbranch_scc1 L3_se1
    s_waitcnt vmcnt(0) lgkmcnt(0)
    v_mfma_f32_4x4x4_16b_bf16 v[32:35], v[30:31], v[28:29], v[20:23] cbsz:4 abid:4
    v_rcp_f32 v66, v66
    v_mfma_f32_4x4x4_16b_bf16 v[36:39], v[30:31], v[28:29], v[20:23] cbsz:4 abid:5
    v_rcp_f32 v67, v67
    v_mfma_f32_4x4x4_16b_bf16 v[32:35], v[26:27], v[80:81], v[32:35]
    v_rcp_f32 v74, v74
    v_mfma_f32_4x4x4_16b_bf16 v[40:43], v[30:31], v[28:29], v[20:23] cbsz:4 abid:6
    v_rcp_f32 v75, v75
    v_mfma_f32_4x4x4_16b_bf16 v[32:35], v[24:25], v[82:83], v[32:35]
    v_mfma_f32_4x4x4_16b_bf16 v[44:47], v[30:31], v[28:29], v[20:23] cbsz:4 abid:7
    v_mfma_f32_4x4x4_16b_bf16 v[36:39], v[26:27], v[84:85], v[36:39]
    v_mfma_f32_4x4x4_16b_bf16 v[40:43], v[26:27], v[88:89], v[40:43]
    s_bitcmp1_b32 s28, 5
    v_mfma_f32_4x4x4_16b_bf16 v[36:39], v[24:25], v[86:87], v[36:39]
    v_exp_f32_e64 v32, v32 clamp
    buffer_load_dword v96, v96, s[8:11], 0 offen
    v_mfma_f32_4x4x4_16b_bf16 v[44:47], v[26:27], v[92:93], v[44:47]
    v_exp_f32_e64 v33, v33 clamp
    buffer_load_dword v97, v97, s[8:11], 0 offen
    v_mfma_f32_4x4x4_16b_bf16 v[40:43], v[24:25], v[90:91], v[40:43]
    v_exp_f32_e64 v34, v34 clamp
    buffer_load_dword v98, v98, s[8:11], 0 offen
    v_mfma_f32_4x4x4_16b_bf16 v[44:47], v[24:25], v[94:95], v[44:47]
    v_exp_f32_e64 v35, v35 clamp
    buffer_load_dword v99, v99, s[8:11], 0 offen
    v_exp_f32_e64 v36, v36 clamp
    buffer_load_dword v100, v100, s[8:11], 0 offen
    v_exp_f32_e64 v37, v37 clamp
    buffer_load_dword v101, v101, s[8:11], 0 offen
    v_exp_f32_e64 v38, v38 clamp
    buffer_load_dword v102, v102, s[8:11], 0 offen
    v_exp_f32_e64 v39, v39 clamp
    buffer_load_dword v103, v103, s[8:11], 0 offen
    v_exp_f32_e64 v40, v40 clamp
    buffer_load_dword v104, v104, s[8:11], 0 offen
    v_exp_f32_e64 v41, v41 clamp
    buffer_load_dword v105, v105, s[8:11], 0 offen
    v_exp_f32_e64 v42, v42 clamp
    buffer_load_dword v106, v106, s[8:11], 0 offen
    v_exp_f32_e64 v43, v43 clamp
    buffer_load_dword v107, v107, s[8:11], 0 offen
    v_exp_f32_e64 v44, v44 clamp
    buffer_load_dword v108, v108, s[8:11], 0 offen
    v_exp_f32_e64 v45, v45 clamp
    buffer_load_dword v109, v109, s[8:11], 0 offen
    v_exp_f32_e64 v46, v46 clamp
    buffer_load_dword v110, v110, s[8:11], 0 offen
    v_exp_f32_e64 v47, v47 clamp
    buffer_load_dword v111, v111, s[8:11], 0 offen
L3_xb1:
    s_cbranch_scc1 L3_sf1
    v_pk_fma_f32 v[18:19], v[64:65], v[66:67], v[18:19]
    v_pk_fma_f32 v[18:19], v[72:73], v[74:75], v[18:19]
L3_fb1:
    ds_read_b128 v[112:115], v15 offset:192
    ds_read_b128 v[116:119], v15 offset:208
    ds_read_b128 v[120:123], v15 offset:224
    ds_read_b128 v[124:127], v15 offset:240
    v_pk_add_f32 v[32:33], v[32:33], v[50:51]
    v_pk_add_f32 v[34:35], v[34:35], v[50:51]
    v_pk_add_f32 v[36:37], v[36:37], v[50:51]
    v_pk_add_f32 v[38:39], v[38:39], v[50:51]
    v_pk_add_f32 v[40:41], v[40:41], v[50:51]
    v_pk_add_f32 v[42:43], v[42:43], v[50:51]
    v_pk_add_f32 v[44:45], v[44:45], v[50:51]
    v_pk_add_f32 v[46:47], v[46:47], v[50:51]
    v_pk_mul_f32 v[80:81], v[80:81], v[34:35]
    v_pk_mul_f32 v[88:89], v[88:89], v[42:43]
    v_pk_mul_f32 v[84:85], v[84:85], v[38:39]
    v_pk_mul_f32 v[92:93], v[92:93], v[46:47]
    v_pk_fma_f32 v[80:81], v[82:83], v[32:33], v[80:81]
    v_pk_fma_f32 v[88:89], v[90:91], v[40:41], v[88:89]
    v_pk_fma_f32 v[84:85], v[86:87], v[36:37], v[84:85]
    v_pk_fma_f32 v[92:93], v[94:95], v[44:45], v[92:93]
    v_pk_mul_f32 v[32:33], v[32:33], v[34:35]
    v_pk_mul_f32 v[40:41], v[40:41], v[42:43]
    v_pk_mul_f32 v[36:37], v[36:37], v[38:39]
    v_pk_mul_f32 v[44:45], v[44:45], v[46:47]
    v_pk_mul_f32 v[80:81], v[80:81], v[36:37]
    v_pk_mul_f32 v[88:89], v[88:89], v[44:45]
    v_pk_mul_f32 v[82:83], v[32:33], v[36:37]
    v_pk_mul_f32 v[90:91], v[40:41], v[44:45]
    v_pk_fma_f32 v[80:81], v[84:85], v[32:33], v[80:81]
    v_pk_fma_f32 v[88:89], v[92:93], v[40:41], v[88:89]
    s_bitcmp1_b32 s28, 8
    s_cbranch_scc1 L3_se2
    s_waitcnt vmcnt(0) lgkmcnt(0)
    v_mfma_f32_4x4x4_16b_bf16 v[32:35], v[30:31], v[28:29], v[20:23] cbsz:4 abid:8
    v_rcp_f32 v82, v82
    v_mfma_f32_4x4x4_16b_bf16 v[36:39], v[30:31], v[28:29], v[20:23] cbsz:4 abid:9
    v_rcp_f32 v83, v83
    v_mfma_f32_4x4x4_16b_bf16 v[32:35], v[26:27], v[96:97], v[32:35]
    v_rcp_f32 v90, v90
    v_mfma_f32_4x4x4_16b_bf16 v[40:43], v[30:31], v[28:29], v[20:23] cbsz:4 abid:10
    v_rcp_f32 v91, v91
    v_mfma_f32_4x4x4_16b_bf16 v[32:35], v[24:25], v[98:99], v[32:35]
    v_mfma_f32_4x4x4_16b_bf16 v[44:47], v[30:31], v[28:29], v[20:23] cbsz:4 abid:11
    v_mfma_f32_4x4x4_16b_bf16 v[36:39], v[26:27], v[100:101], v[36:39]
    v_mfma_f32_4x4x4_16b_bf16 v[40:43], v[26:27], v[104:105], v[40:43]
    s_bitcmp1_b32 s28, 9
    v_mfma_f32_4x4x4_16b_bf16 v[36:39], v[24:25], v[102:103], v[36:39]
    v_exp_f32_e64 v32, v32 clamp
    buffer_load_dword v112, v112, s[8:11], 0 offen
    v_mfma_f32_4x4x4_16b_bf16 v[44:47], v[26:27], v[108:109], v[44:47]
    v_exp_f32_e64 v33, v33 clamp
    buffer_load_dword v113, v113, s[8:11], 0 offen
    v_mfma_f32_4x4x4_16b_bf16 v[40:43], v[24:25], v[106:107], v[40:43]
    v_exp_f32_e64 v34, v34 clamp
    buffer_load_dword v114, v114, s[8:11], 0 offen
    v_mfma_f32_4x4x4_16b_bf16 v[44:47], v[24:25], v[110:111], v[44:47]
    v_exp_f32_e64 v35, v35 clamp
    buffer_load_dword v115, v115, s[8:11], 0 offen
    v_exp_f32_e64 v36, v36 clamp
    buffer_load_dword v116, v116, s[8:11], 0 offen
    v_exp_f32_e64 v37, v37 clamp
    buffer_load_dword v117, v117, s[8:11], 0 offen
    v_exp_f32_e64 v38, v38 clamp
    buffer_load_dword v118, v118, s[8:11], 0 offen
    v_exp_f32_e64 v39, v39 clamp
    buffer_load_dword v119, v119, s[8:11], 0 offen
    v_exp_f32_e64 v40, v40 clamp
    buffer_load_dword v120, v120, s[8:11], 0 offen
    v_exp_f32_e64 v41, v41 clamp
    buffer_load_dword v121, v121, s[8:11], 0 offen
    v_exp_f32_e64 v42, v42 clamp
    buffer_load_dword v122, v122, s[8:11], 0 offen
    v_exp_f32_e64 v43, v43 clamp
    buffer_load_dword v123, v123, s[8:11], 0 offen
    v_exp_f32_e64 v44, v44 clamp
    buffer_load_dword v124, v124, s[8:11], 0 offen
    v_exp_f32_e64 v45, v45 clamp
    buffer_load_dword v125, v125, s[8:11], 0 offen
    v_exp_f32_e64 v46, v46 clamp
    buffer_load_dword v126, v126, s[8:11], 0 offen
    v_exp_f32_e64 v47, v47 clamp
    buffer_load_dword v127, v127, s[8:11], 0 offen
L3_xb2:
    s_cbranch_scc1 L3_sf2
    v_pk_fma_f32 v[18:19], v[80:81], v[82:83], v[18:19]
    v_pk_fma_f32 v[18:19], v[88:89], v[90:91], v[18:19]
L3_fb2:
    ds_read_b128 v[64:67], v15 offset:256
    ds_read_b128 v[68:71], v15 offset:272
    ds_read_b128 v[72:75], v15 offset:288
    ds_read_b128 v[76:79], v15 offset:304
    v_pk_add_f32 v[32:33], v[32:33], v[50:51]
    v_pk_add_f32 v[34:35], v[34:35], v[50:51]
    v_pk_add_f32 v[36:37], v[36:37], v[50:51]
    v_pk_add_f32 v[38:39], v[38:39], v[50:51]
    v_pk_add_f32 v[40:41], v[40:41], v[50:51]
    v_pk_add_f32 v[42:43], v[42:43], v[50:51]
    v_pk_add_f32 v[44:45], v[44:45], v[50:51]
    v_pk_add_f32 v[46:47], v[46:47], v[50:51]
    v_pk_mul_f32 v[96:97], v[96:97], v[34:35]
    v_pk_mul_f32 v[104:105], v[104:105], v[42:43]
    v_pk_mul_f32 v[100:101], v[100:101], v[38:39]
    v_pk_mul_f32 v[108:109], v[108:109], v[46:47]
    v_pk_fma_f32 v[96:97], v[98:99], v[32:33], v[96:97]
    v_pk_fma_f32 v[104:105], v[106:107], v[40:41], v[104:105]
    v_pk_fma_f32 v[100:101], v[102:103], v[36:37], v[100:101]
    v_pk_fma_f32 v[108:109], v[110:111], v[44:45], v[108:109]
    v_pk_mul_f32 v[32:33], v[32:33], v[34:35]
    v_pk_mul_f32 v[40:41], v[40:41], v[42:43]
    v_pk_mul_f32 v[36:37], v[36:37], v[38:39]
    v_pk_mul_f32 v[44:45], v[44:45], v[46:47]
    v_pk_mul_f32 v[96:97], v[96:97], v[36:37]
    v_pk_mul_f32 v[104:105], v[104:105], v[44:45]
    v_pk_mul_f32 v[98:99], v[32:33], v[36:37]
    v_pk_mul_f32 v[106:107], v[40:41], v[44:45]
    v_pk_fma_f32 v[96:97], v[100:101], v[32:33], v[96:97]
    v_pk_fma_f32 v[104:105], v[108:109], v[40:41], v[104:105]
    s_bitcmp1_b32 s28, 12
    s_cbranch_scc1 L3_se3
    s_waitcnt vmcnt(0) lgkmcnt(0)
    v_mfma_f32_4x4x4_16b_bf16 v[32:35], v[30:31], v[28:29], v[20:23] cbsz:4 abid:12
    v_rcp_f32 v98, v98
    v_mfma_f32_4x4x4_16b_bf16 v[36:39], v[30:31], v[28:29], v[20:23] cbsz:4 abid:13
    v_rcp_f32 v99, v99
    v_mfma_f32_4x4x4_16b_bf16 v[32:35], v[26:27], v[112:113], v[32:35]
    v_rcp_f32 v106, v106
    v_mfma_f32_4x4x4_16b_bf16 v[40:43], v[30:31], v[28:29], v[20:23] cbsz:4 abid:14
    v_rcp_f32 v107, v107
    v_mfma_f32_4x4x4_16b_bf16 v[32:35], v[24:25], v[114:115], v[32:35]
    v_mfma_f32_4x4x4_16b_bf16 v[44:47], v[30:31], v[28:29], v[20:23] cbsz:4 abid:15
    v_mfma_f32_4x4x4_16b_bf16 v[36:39], v[26:27], v[116:117], v[36:39]
    v_mfma_f32_4x4x4_16b_bf16 v[40:43], v[26:27], v[120:121], v[40:43]
    s_bitcmp1_b32 s28, 13
    v_mfma_f32_4x4x4_16b_bf16 v[36:39], v[24:25], v[118:119], v[36:39]
    v_exp_f32_e64 v32, v32 clamp
    buffer_load_dword v64, v64, s[8:11], 0 offen
    v_mfma_f32_4x4x4_16b_bf16 v[44:47], v[26:27], v[124:125], v[44:47]
    v_exp_f32_e64 v33, v33 clamp
    buffer_load_dword v65, v65, s[8:11], 0 offen
    v_mfma_f32_4x4x4_16b_bf16 v[40:43], v[24:25], v[122:123], v[40:43]
    v_exp_f32_e64 v34, v34 clamp
    buffer_load_dword v66, v66, s[8:11], 0 offen
    v_mfma_f32_4x4x4_16b_bf16 v[44:47], v[24:25], v[126:127], v[44:47]
    v_exp_f32_e64 v35, v35 clamp
    buffer_load_dword v67, v67, s[8:11], 0 offen
    v_exp_f32_e64 v36, v36 clamp
    buffer_load_dword v68, v68, s[8:11], 0 offen
    v_exp_f32_e64 v37, v37 clamp
    buffer_load_dword v69, v69, s[8:11], 0 offen
    v_exp_f32_e64 v38, v38 clamp
    buffer_load_dword v70, v70, s[8:11], 0 offen
    v_exp_f32_e64 v39, v39 clamp
    buffer_load_dword v71, v71, s[8:11], 0 offen
    v_exp_f32_e64 v40, v40 clamp
    buffer_load_dword v72, v72, s[8:11], 0 offen
    v_exp_f32_e64 v41, v41 clamp
    buffer_load_dword v73, v73, s[8:11], 0 offen
    v_exp_f32_e64 v42, v42 clamp
    buffer_load_dword v74, v74, s[8:11], 0 offen
    v_exp_f32_e64 v43, v43 clamp
    buffer_load_dword v75, v75, s[8:11], 0 offen
    v_exp_f32_e64 v44, v44 clamp
    buffer_load_dword v76, v76, s[8:11], 0 offen
    v_exp_f32_e64 v45, v45 clamp
    buffer_load_dword v77, v77, s[8:11], 0 offen
    v_exp_f32_e64 v46, v46 clamp
    buffer_load_dword v78, v78, s[8:11], 0 offen
    v_exp_f32_e64 v47, v47 clamp
    buffer_load_dword v79, v79, s[8:11], 0 offen
L3_xb3:
    s_cbranch_scc1 L3_sf3
    v_pk_fma_f32 v[18:19], v[96:97], v[98:99], v[18:19]
    v_pk_fma_f32 v[18:19], v[104:105], v[106:107], v[18:19]
L3_fb3:
    ds_read_b128 v[80:83], v15 offset:320
    ds_read_b128 v[84:87], v15 offset:336
    ds_read_b128 v[88:91], v15 offset:352
    ds_read_b128 v[92:95], v15 offset:368
    v_pk_add_f32 v[32:33], v[32:33], v[50:51]
    v_pk_add_f32 v[34:35], v[34:35], v[50:51]
    v_pk_add_f32 v[36:37], v[36:37], v[50:51]
    v_pk_add_f32 v[38:39], v[38:39], v[50:51]
    v_pk_add_f32 v[40:41], v[40:41], v[50:51]
    v_pk_add_f32 v[42:43], v[42:43], v[50:51]
    v_pk_add_f32 v[44:45], v[44:45], v[50:51]
    v_pk_add_f32 v[46:47], v[46:47], v[50:51]
    v_pk_mul_f32 v[112:113], v[112:113], v[34:35]
    v_pk_mul_f32 v[120:121], v[120:121], v[42:43]
    v_pk_mul_f32 v[116:117], v[116:117], v[38:39]
    v_pk_mul_f32 v[124:125], v[124:125], v[46:47]
    v_pk_fma_f32 v[112:113], v[114:115], v[32:33], v[112:113]
    v_pk_fma_f32 v[120:121], v[122:123], v[40:41], v[120:121]
    v_pk_fma_f32 v[116:117], v[118:119], v[36:37], v[116:117]
    v_pk_fma_f32 v[124:125], v[126:127], v[44:45], v[124:125]
    v_pk_mul_f32 v[32:33], v[32:33], v[34:35]
    v_pk_mul_f32 v[40:41], v[40:41], v[42:43]
    v_pk_mul_f32 v[36:37], v[36:37], v[38:39]
    v_pk_mul_f32 v[44:45], v[44:45], v[46:47]
    v_pk_mul_f32 v[112:113], v[112:113], v[36:37]
    v_pk_mul_f32 v[120:121], v[120:121], v[44:45]
    v_pk_mul_f32 v[114:115], v[32:33], v[36:37]
    v_pk_mul_f32 v[122:123], v[40:41], v[44:45]
    v_pk_fma_f32 v[112:113], v[116:117], v[32:33], v[112:113]
    v_pk_fma_f32 v[120:121], v[124:125], v[40:41], v[120:121]
    v_add_u32 v15, 0x100, v15
    v_mov_b64 v[30:31], v[54:55]
    v_mov_b64 v[54:55], v[56:57]
    v_mov_b64 v[56:57], v[58:59]
    s_lshr_b64 s[28:29], s[28:29], 16
    s_lshr_b64 s[76:77], s[76:77], 16
    s_lshr_b64 s[4:5], s[4:5], 16
    s_lshr_b32 s6, s6, 4
    s_branch L2_loop
L3_last0:
    v_rcp_f32 v66, v66
    v_rcp_f32 v67, v67
    v_rcp_f32 v74, v74
    v_rcp_f32 v75, v75
    s_cmp_lg_u32 s23, 0
    s_cbranch_scc1 L3_sfe0
    v_pk_fma_f32 v[18:19], v[64:65], v[66:67], v[18:19]
    v_pk_fma_f32 v[18:19], v[72:73], v[74:75], v[18:19]
L3_fbe0:
L2_last:
    v_add_f32 v52, v18, v19
    v_mul_f32 v52, 0x30000000, v52
    v_cvt_f64_f32 v[16:17], v52
    ds_add_f64 v12, v[16:17] offset:13312
L2_done:
    s_waitcnt vmcnt(0) lgkmcnt(0)
    s_barrier
    s_or_b32 s84, s25, s20
    s_cbranch_scc1 L2_next
    v_lshlrev_b32 v1, 5, v0
    ds_read_b128 v[80:83], v1 offset:13312
    ds_read_b128 v[84:87], v1 offset:13328
    v_cmp_gt_u32 vcc, 784, v0
    s_lshl_b32 s93, s78, 7
    v_lshl_add_u32 v2, v0, 3, s93
    s_and_saveexec_b64 s[94:95], vcc
    s_cbranch_execz L2_fin
    s_waitcnt lgkmcnt(0)
    v_cvt_f32_f64 v64, v[80:81]
    v_cvt_f32_f64 v65, v[82:83]
    v_cvt_f32_f64 v66, v[84:85]
    v_cvt_f32_f64 v67, v[86:87]
    v_mul_f32 v72, 0xbfb8aa3b, v64
    v_mul_f32 v73, 0xbfb8aa3b, v65
    v_mul_f32 v74, 0xbfb8aa3b, v66
    v_mul_f32 v75, 0xbfb8aa3b, v67
    v_exp_f32 v72, v72
    v_exp_f32 v73, v73
    v_exp_f32 v74, v74
    v_exp_f32 v75, v75
    v_add_f32 v72, 1.0, v72
    v_add_f32 v73, 1.0, v73
    v_add_f32 v74, 1.0, v74
    v_add_f32 v75, 1.0, v75
    v_rcp_f32 v72, v72
    v_rcp_f32 v73, v73
    v_rcp_f32 v74, v74
    v_rcp_f32 v75, v75
    v_mul_f32 v64, v64, v72
    v_mul_f32 v65, v65, v73
    v_mul_f32 v66, v66, v74
    v_mul_f32 v67, v67, v75
    v_cvt_pk_bf16_f32 v72, v64, v65
    v_cvt_pk_bf16_f32 v73, v66, v67
    buffer_store_dwordx2 v[72:73], v2, s[16:19], 0 offen
L2_fin:
L_end:
    s_endpgm
L2_tagno:
    v_mov_b32 v5, 151320
    ds_write_b32 v5, v5
    s_mov_b32 s87, 1
    s_branch L2_tagok
L2_wf:
    buffer_load_dwordx4 v[112:115], v7, s[12:15], s82 offen sc1
    s_add_u32 s82, s82, 16384
    s_branch L2_f
L2_gno:
    v_mov_b32 v5, 151320
    ds_write_b32 v5, v5
    v_mov_b32 v2, 0
    s_branch L2_g
L9_alone:
    s_load_dwordx8 s[84:91], s[0:1], 0
    s_load_dwordx2 s[92:93], s[0:1], 40
    s_waitcnt vmcnt(0) lgkmcnt(0)
    s_mov_b32 s32, s84
    s_and_b32 s33, s85, 0xffff
    s_mov_b32 s34, 1600000
    s_mov_b32 s35, 0x00020000
    s_mov_b32 s36, s86
    s_and_b32 s37, s87, 0xffff
    s_mov_b32 s38, 6400000
    s_mov_b32 s39, 0x00020000
    s_mov_b32 s40, s88
    s_and_b32 s41, s89, 0xffff
    s_mov_b32 s42, 3200000
    s_mov_b32 s43, 0x00020000
    s_mov_b32 s44, s90
    s_and_b32 s45, s91, 0xffff
    s_mov_b32 s46, 3200000
    s_mov_b32 s47, 0x00020000
    s_mov_b32 s56, s92
    s_and_b32 s57, s93, 0xffff
    s_mov_b32 s58, 8192
    s_mov_b32 s59, 0x00020000
    v_lshlrev_b32 v32, 1, v10
    v_lshlrev_b32 v33, 16, v28
    v_and_b32 v34, 0xffff0000, v28
    v_lshlrev_b32 v35, 16, v29
    v_and_b32 v36, 0xffff0000, v29
    v_lshlrev_b32 v37, 2, v0
    s_mov_b32 s84, 782
L9_scan:
    v_lshlrev_b32 v38, 1, v37
    buffer_load_dword v40, v37, s[44:47], 0 offen
    buffer_load_dword v41, v37, s[40:43], 0 offen
    buffer_load_dwordx2 v[42:43], v38, s[36:39], 0 offen
    s_mov_b32 s85, 3200000
    v_cmp_gt_u32 s[86:87], s85, v37
    s_waitcnt vmcnt(0)
    v_subrev_u32 v40, s78, v40
    v_cmp_gt_u32 vcc, 49, v40
    s_and_b64 s[86:87], s[86:87], vcc
L9_edge:
    s_cmp_eq_u64 s[86:87], 0
    s_cbranch_scc1 L9_next
    s_ff1_i32_b64 s85, s[86:87]
    s_bitset0_b64 s[86:87], s85
    v_readlane_b32 s88, v40, s85
    v_readlane_b32 s89, v41, s85
    v_readlane_b32 s90, v42, s85
    v_readlane_b32 s91, v43, s85
    s_lshl_b32 s89, s89, 7
    v_add_u32 v44, s89, v32
    buffer_load_ushort v45, v44, s[32:35], 0 offen
    s_lshl_b32 s88, s88, 8
    v_lshl_add_u32 v44, v10, 2, s88
    ds_read_b32 v46, v44 offset:0
    v_mov_b32 v52, 0
    v_mov_b32 v53, 0
    s_mov_b32 s92, 0
    s_waitcnt vmcnt(0)
    v_lshlrev_b32 v45, 16, v45
L9_k:
    s_lshl_b32 s93, s92, 7
    s_add_u32 s94, s93, 8192
    buffer_load_ushort v54, v32, s[52:55], s94 offen
    buffer_load_ushort v55, v32, s[56:59], s93 offen
    v_readlane_b32 s95, v45, s92
    s_waitcnt vmcnt(0)
    v_lshlrev_b32 v54, 16, v54
    v_lshlrev_b32 v55, 16, v55
    v_fmac_f32 v52, s95, v54
    v_fmac_f32 v53, s95, v55
    s_add_u32 s92, s92, 1
    s_cmp_lt_u32 s92, 64
    s_cbranch_scc1 L9_k
    s_lshl_b32 s92, s90, 16
    s_and_b32 s93, s90, 0xffff0000
    s_lshl_b32 s94, s91, 16
    s_and_b32 s95, s91, 0xffff0000
    s_waitcnt lgkmcnt(0)
    v_add_f32 v46, 0x41f80000, v46
    v_fmac_f32 v46, 0xbfb8aa3b, v52
    v_fmac_f32 v46, s92, v33
    v_fmac_f32 v46, s93, v34
    v_fmac_f32 v46, s94, v35
    v_fmac_f32 v46, s95, v36
    v_exp_f32 v46, v46
    s_nop 0
    v_add_f32 v46, 1.0, v46
    v_rcp_f32 v46, v46
    v_add_u32 v44, v44, v44
    v_mul_f32 v46, v46, v53
    v_cvt_f64_f32 v[54:55], v46
    ds_add_f64 v44, v[54:55] offset:13312
    s_branch L9_edge
L9_next:
    v_add_u32 v37, 0x1000, v37
    s_sub_u32 s84, s84, 1
    s_cmp_lg_u32 s84, 0
    s_cbranch_scc1 L9_scan
    s_mov_b32 s25, 0
    s_mov_b32 s20, 0
    s_branch L2_done
L2_over:
    s_movk_i32 s84, 296
    s_branch L2_cap
L2_pend:
    v_cmp_le_u32 vcc, s84, v67
    s_and_b64 s[32:33], s[32:33], vcc
    v_cmp_le_u32 vcc, s84, v71
    s_and_b64 s[34:35], s[34:35], vcc
    v_cmp_le_u32 vcc, s84, v75
    s_and_b64 s[36:37], s[36:37], vcc
    v_cmp_le_u32 vcc, s84, v79
    s_and_b64 s[38:39], s[38:39], vcc
    v_cmp_le_u32 vcc, s84, v83
    s_and_b64 s[40:41], s[40:41], vcc
    v_cmp_le_u32 vcc, s84, v87
    s_and_b64 s[42:43], s[42:43], vcc
    v_cmp_le_u32 vcc, s84, v91
    s_and_b64 s[44:45], s[44:45], vcc
    v_cmp_le_u32 vcc, s84, v95
    s_and_b64 s[46:47], s[46:47], vcc
    s_branch L2_pendb
L3_se0:
    s_bitcmp1_b32 s28, 3
    s_cbranch_scc1 L3_last3
    s_bitcmp1_b32 s28, 2
    s_waitcnt lgkmcnt(0)
    s_cbranch_scc1 L3_nl0
    buffer_load_dword v80, v80, s[8:11], 0 offen
    buffer_load_dword v81, v81, s[8:11], 0 offen
    buffer_load_dword v82, v82, s[8:11], 0 offen
    buffer_load_dword v83, v83, s[8:11], 0 offen
    buffer_load_dword v84, v84, s[8:11], 0 offen
    buffer_load_dword v85, v85, s[8:11], 0 offen
    buffer_load_dword v86, v86, s[8:11], 0 offen
    buffer_load_dword v87, v87, s[8:11], 0 offen
    buffer_load_dword v88, v88, s[8:11], 0 offen
    buffer_load_dword v89, v89, s[8:11], 0 offen
    buffer_load_dword v90, v90, s[8:11], 0 offen
    buffer_load_dword v91, v91, s[8:11], 0 offen
    buffer_load_dword v92, v92, s[8:11], 0 offen
    buffer_load_dword v93, v93, s[8:11], 0 offen
    buffer_load_dword v94, v94, s[8:11], 0 offen
    buffer_load_dword v95, v95, s[8:11], 0 offen
    s_waitcnt vmcnt(16)
L3_lb0:
    s_bitcmp1_b32 s6, 0
    s_cbranch_scc1 L3_pd0
L3_pe0:
    s_bitcmp1_b32 s76, 0
    s_cbranch_scc1 L3_ps0_0
L3_pb0_0:
    v_mov_b32 v20, v21
    v_mov_b32 v22, v21
    s_bitcmp1_b32 s76, 1
    s_cbranch_scc1 L3_ps0_1
L3_pb0_1:
    v_mov_b32 v23, v21
    s_nop 1
    v_mfma_f32_4x4x4_16b_bf16 v[32:35], v[30:31], v[28:29], v[20:23] cbsz:4 abid:0
    v_rcp_f32 v114, v114
    v_mfma_f32_4x4x4_16b_bf16 v[36:39], v[30:31], v[28:29], v[20:23] cbsz:4 abid:1
    v_rcp_f32 v115, v115
    v_mfma_f32_4x4x4_16b_bf16 v[32:35], v[26:27], v[64:65], v[32:35]
    v_rcp_f32 v122, v122
    s_bitcmp1_b32 s76, 2
    s_cbranch_scc1 L3_ps0_2
L3_pb0_2:
    v_mov_b32 v20, v21
    v_mov_b32 v22, v21
    s_bitcmp1_b32 s76, 3
    s_cbranch_scc1 L3_ps0_3
L3_pb0_3:
    v_mov_b32 v23, v21
    s_nop 1
    v_mfma_f32_4x4x4_16b_bf16 v[40:43], v[30:31], v[28:29], v[20:23] cbsz:4 abid:2
    v_rcp_f32 v123, v123
    v_mfma_f32_4x4x4_16b_bf16 v[32:35], v[24:25], v[66:67], v[32:35]
    v_mfma_f32_4x4x4_16b_bf16 v[44:47], v[30:31], v[28:29], v[20:23] cbsz:4 abid:3
    v_mfma_f32_4x4x4_16b_bf16 v[36:39], v[26:27], v[68:69], v[36:39]
    v_mfma_f32_4x4x4_16b_bf16 v[40:43], v[26:27], v[72:73], v[40:43]
    v_mov_b32 v20, v21
    v_mov_b32 v22, v21
    s_bitcmp1_b32 s28, 1
    v_mfma_f32_4x4x4_16b_bf16 v[36:39], v[24:25], v[70:71], v[36:39]
    v_exp_f32_e64 v32, v32 clamp
    v_mfma_f32_4x4x4_16b_bf16 v[44:47], v[26:27], v[76:77], v[44:47]
    v_exp_f32_e64 v33, v33 clamp
    v_mfma_f32_4x4x4_16b_bf16 v[40:43], v[24:25], v[74:75], v[40:43]
    v_exp_f32_e64 v34, v34 clamp
    v_mfma_f32_4x4x4_16b_bf16 v[44:47], v[24:25], v[78:79], v[44:47]
    v_exp_f32_e64 v35, v35 clamp
    v_exp_f32_e64 v36, v36 clamp
    v_exp_f32_e64 v37, v37 clamp
    v_exp_f32_e64 v38, v38 clamp
    v_exp_f32_e64 v39, v39 clamp
    v_exp_f32_e64 v40, v40 clamp
    v_exp_f32_e64 v41, v41 clamp
    v_exp_f32_e64 v42, v42 clamp
    v_exp_f32_e64 v43, v43 clamp
    v_exp_f32_e64 v44, v44 clamp
    v_exp_f32_e64 v45, v45 clamp
    v_exp_f32_e64 v46, v46 clamp
    v_exp_f32_e64 v47, v47 clamp
    s_branch L3_xb0
L3_nl0:
    s_waitcnt vmcnt(0)
    s_branch L3_lb0
L3_pd0:
    s_sub_u32 s7, s7, 1
    s_setprio 0
    s_cmp_eq_u32 s7, 0
    s_cbranch_scc1 L3_pe0
    s_setprio 1
    s_cmp_eq_u32 s7, 1
    s_cbranch_scc1 L3_pe0
    s_setprio 2
    s_branch L3_pe0
L3_ps0_0:
    s_waitcnt lgkmcnt(0)
    v_mov_b32 v21, v48
    v_add_u32 v13, 0x100, v13
    ds_read_b32 v48, v13 offset:0
    s_branch L3_pb0_0
L3_ps0_1:
    s_waitcnt lgkmcnt(0)
    v_mov_b32 v21, v48
    v_add_u32 v13, 0x100, v13
    ds_read_b32 v48, v13 offset:0
    s_branch L3_pb0_1
L3_ps0_2:
    s_waitcnt lgkmcnt(0)
    v_mov_b32 v21, v48
    v_add_u32 v13, 0x100, v13
    ds_read_b32 v48, v13 offset:0
    s_branch L3_pb0_2
L3_ps0_3:
    s_waitcnt lgkmcnt(0)
    v_mov_b32 v21, v48
    v_add_u32 v13, 0x100, v13
    ds_read_b32 v48, v13 offset:0
    s_branch L3_pb0_3
L3_sf0:
    s_bitcmp1_b32 s4, 0
    s_cbranch_scc0 L3_sk0_0
    v_add_f32 v52, v18, v19
    v_mul_f32 v52, 0x30000000, v52
    v_cvt_f64_f32 v[16:17], v52
    ds_add_f64 v12, v[16:17] offset:13312
    v_add_u32 v12, 0x200, v12
    v_mov_b32 v18, 0
    v_mov_b32 v19, 0
L3_sk0_0:
    v_fmac_f32 v18, v112, v114
    s_bitcmp1_b32 s4, 1
    s_cbranch_scc0 L3_sk0_1
    v_add_f32 v52, v18, v19
    v_mul_f32 v52, 0x30000000, v52
    v_cvt_f64_f32 v[16:17], v52
    ds_add_f64 v12, v[16:17] offset:13312
    v_add_u32 v12, 0x200, v12
    v_mov_b32 v18, 0
    v_mov_b32 v19, 0
L3_sk0_1:
    v_fmac_f32 v19, v113, v115
    s_bitcmp1_b32 s4, 2
    s_cbranch_scc0 L3_sk0_2
    v_add_f32 v52, v18, v19
    v_mul_f32 v52, 0x30000000, v52
    v_cvt_f64_f32 v[16:17], v52
    ds_add_f64 v12, v[16:17] offset:13312
    v_add_u32 v12, 0x200, v12
    v_mov_b32 v18, 0
    v_mov_b32 v19, 0
L3_sk0_2:
    v_fmac_f32 v18, v120, v122
    s_bitcmp1_b32 s4, 3
    s_cbranch_scc0 L3_sk0_3
    v_add_f32 v52, v18, v19
    v_mul_f32 v52, 0x30000000, v52
    v_cvt_f64_f32 v[16:17], v52
    ds_add_f64 v12, v[16:17] offset:13312
    v_add_u32 v12, 0x200, v12
    v_mov_b32 v18, 0
    v_mov_b32 v19, 0
L3_sk0_3:
    v_fmac_f32 v19, v121, v123
    s_branch L3_fb0
L3_se1:
    s_bitcmp1_b32 s28, 7
    s_cbranch_scc1 L3_last0
    s_bitcmp1_b32 s28, 6
    s_waitcnt lgkmcnt(0)
    s_cbranch_scc1 L3_nl1
    buffer_load_dword v96, v96, s[8:11], 0 offen
    buffer_load_dword v97, v97, s[8:11], 0 offen
    buffer_load_dword v98, v98, s[8:11], 0 offen
    buffer_load_dword v99, v99, s[8:11], 0 offen
    buffer_load_dword v100, v100, s[8:11], 0 offen
    buffer_load_dword v101, v101, s[8:11], 0 offen
    buffer_load_dword v102, v102, s[8:11], 0 offen
    buffer_load_dword v103, v103, s[8:11], 0 offen
    buffer_load_dword v104, v104, s[8:11], 0 offen
    buffer_load_dword v105, v105, s[8:11], 0 offen
    buffer_load_dword v106, v106, s[8:11], 0 offen
    buffer_load_dword v107, v107, s[8:11], 0 offen
    buffer_load_dword v108, v108, s[8:11], 0 offen
    buffer_load_dword v109, v109, s[8:11], 0 offen
    buffer_load_dword v110, v110, s[8:11], 0 offen
    buffer_load_dword v111, v111, s[8:11], 0 offen
    s_waitcnt vmcnt(16)
L3_lb1:
    s_bitcmp1_b32 s6, 1
    s_cbranch_scc1 L3_pd1
L3_pe1:
    s_bitcmp1_b32 s76, 4
    s_cbranch_scc1 L3_ps1_0
L3_pb1_0:
    v_mov_b32 v20, v21
    v_mov_b32 v22, v21
    s_bitcmp1_b32 s76, 5
    s_cbranch_scc1 L3_ps1_1
L3_pb1_1:
    v_mov_b32 v23, v21
    s_nop 1
    v_mfma_f32_4x4x4_16b_bf16 v[32:35], v[30:31], v[28:29], v[20:23] cbsz:4 abid:4
    v_rcp_f32 v66, v66
    v_mfma_f32_4x4x4_16b_bf16 v[36:39], v[30:31], v[28:29], v[20:23] cbsz:4 abid:5
    v_rcp_f32 v67, v67
    v_mfma_f32_4x4x4_16b_bf16 v[32:35], v[26:27], v[80:81], v[32:35]
    v_rcp_f32 v74, v74
    s_bitcmp1_b32 s76, 6
    s_cbranch_scc1 L3_ps1_2
L3_pb1_2:
    v_mov_b32 v20, v21
    v_mov_b32 v22, v21
    s_bitcmp1_b32 s76, 7
    s_cbranch_scc1 L3_ps1_3
L3_pb1_3:
    v_mov_b32 v23, v21
    s_nop 1
    v_mfma_f32_4x4x4_16b_bf16 v[40:43], v[30:31], v[28:29], v[20:23] cbsz:4 abid:6
    v_rcp_f32 v75, v75
    v_mfma_f32_4x4x4_16b_bf16 v[32:35], v[24:25], v[82:83], v[32:35]
    v_mfma_f32_4x4x4_16b_bf16 v[44:47], v[30:31], v[28:29], v[20:23] cbsz:4 abid:7
    v_mfma_f32_4x4x4_16b_bf16 v[36:39], v[26:27], v[84:85], v[36:39]
    v_mfma_f32_4x4x4_16b_bf16 v[40:43], v[26:27], v[88:89], v[40:43]
    v_mov_b32 v20, v21
    v_mov_b32 v22, v21
    s_bitcmp1_b32 s28, 5
    v_mfma_f32_4x4x4_16b_bf16 v[36:39], v[24:25], v[86:87], v[36:39]
    v_exp_f32_e64 v32, v32 clamp
    v_mfma_f32_4x4x4_16b_bf16 v[44:47], v[26:27], v[92:93], v[44:47]
    v_exp_f32_e64 v33, v33 clamp
    v_mfma_f32_4x4x4_16b_bf16 v[40:43], v[24:25], v[90:91], v[40:43]
    v_exp_f32_e64 v34, v34 clamp
    v_mfma_f32_4x4x4_16b_bf16 v[44:47], v[24:25], v[94:95], v[44:47]
    v_exp_f32_e64 v35, v35 clamp
    v_exp_f32_e64 v36, v36 clamp
    v_exp_f32_e64 v37, v37 clamp
    v_exp_f32_e64 v38, v38 clamp
    v_exp_f32_e64 v39, v39 clamp
    v_exp_f32_e64 v40, v40 clamp
    v_exp_f32_e64 v41, v41 clamp
    v_exp_f32_e64 v42, v42 clamp
    v_exp_f32_e64 v43, v43 clamp
    v_exp_f32_e64 v44, v44 clamp
    v_exp_f32_e64 v45, v45 clamp
    v_exp_f32_e64 v46, v46 clamp
    v_exp_f32_e64 v47, v47 clamp
    s_branch L3_xb1
L3_nl1:
    s_waitcnt vmcnt(0)
    s_branch L3_lb1
L3_pd1:
    s_sub_u32 s7, s7, 1
    s_setprio 0
    s_cmp_eq_u32 s7, 0
    s_cbranch_scc1 L3_pe1
    s_setprio 1
    s_cmp_eq_u32 s7, 1
    s_cbranch_scc1 L3_pe1
    s_setprio 2
    s_branch L3_pe1
L3_ps1_0:
    s_waitcnt lgkmcnt(0)
    v_mov_b32 v21, v48
    v_add_u32 v13, 0x100, v13
    ds_read_b32 v48, v13 offset:0
    s_branch L3_pb1_0
L3_ps1_1:
    s_waitcnt lgkmcnt(0)
    v_mov_b32 v21, v48
    v_add_u32 v13, 0x100, v13
    ds_read_b32 v48, v13 offset:0
    s_branch L3_pb1_1
L3_ps1_2:
    s_waitcnt lgkmcnt(0)
    v_mov_b32 v21, v48
    v_add_u32 v13, 0x100, v13
    ds_read_b32 v48, v13 offset:0
    s_branch L3_pb1_2
L3_ps1_3:
    s_waitcnt lgkmcnt(0)
    v_mov_b32 v21, v48
    v_add_u32 v13, 0x100, v13
    ds_read_b32 v48, v13 offset:0
    s_branch L3_pb1_3
L3_sf1:
    s_bitcmp1_b32 s4, 4
    s_cbranch_scc0 L3_sk1_0
    v_add_f32 v52, v18, v19
    v_mul_f32 v52, 0x30000000, v52
    v_cvt_f64_f32 v[16:17], v52
    ds_add_f64 v12, v[16:17] offset:13312
    v_add_u32 v12, 0x200, v12
    v_mov_b32 v18, 0
    v_mov_b32 v19, 0
L3_sk1_0:
    v_fmac_f32 v18, v64, v66
    s_bitcmp1_b32 s4, 5
    s_cbranch_scc0 L3_sk1_1
    v_add_f32 v52, v18, v19
    v_mul_f32 v52, 0x30000000, v52
    v_cvt_f64_f32 v[16:17], v52
    ds_add_f64 v12, v[16:17] offset:13312
    v_add_u32 v12, 0x200, v12
    v_mov_b32 v18, 0
    v_mov_b32 v19, 0
L3_sk1_1:
    v_fmac_f32 v19, v65, v67
    s_bitcmp1_b32 s4, 6
    s_cbranch_scc0 L3_sk1_2
    v_add_f32 v52, v18, v19
    v_mul_f32 v52, 0x30000000, v52
    v_cvt_f64_f32 v[16:17], v52
    ds_add_f64 v12, v[16:17] offset:13312
    v_add_u32 v12, 0x200, v12
    v_mov_b32 v18, 0
    v_mov_b32 v19, 0
L3_sk1_2:
    v_fmac_f32 v18, v72, v74
    s_bitcmp1_b32 s4, 7
    s_cbranch_scc0 L3_sk1_3
    v_add_f32 v52, v18, v19
    v_mul_f32 v52, 0x30000000, v52
    v_cvt_f64_f32 v[16:17], v52
    ds_add_f64 v12, v[16:17] offset:13312
    v_add_u32 v12, 0x200, v12
    v_mov_b32 v18, 0
    v_mov_b32 v19, 0
L3_sk1_3:
    v_fmac_f32 v19, v73, v75
    s_branch L3_fb1
L3_se2:
    s_bitcmp1_b32 s28, 11
    s_cbranch_scc1 L3_last1
    s_bitcmp1_b32 s28, 10
    s_waitcnt lgkmcnt(0)
    s_cbranch_scc1 L3_nl2
    buffer_load_dword v112, v112, s[8:11], 0 offen
    buffer_load_dword v113, v113, s[8:11], 0 offen
    buffer_load_dword v114, v114, s[8:11], 0 offen
    buffer_load_dword v115, v115, s[8:11], 0 offen
    buffer_load_dword v116, v116, s[8:11], 0 offen
    buffer_load_dword v117, v117, s[8:11], 0 offen
    buffer_load_dword v118, v118, s[8:11], 0 offen
    buffer_load_dword v119, v119, s[8:11], 0 offen
    buffer_load_dword v120, v120, s[8:11], 0 offen
    buffer_load_dword v121, v121, s[8:11], 0 offen
    buffer_load_dword v122, v122, s[8:11], 0 offen
    buffer_load_dword v123, v123, s[8:11], 0 offen
    buffer_load_dword v124, v124, s[8:11], 0 offen
    buffer_load_dword v125, v125, s[8:11], 0 offen
    buffer_load_dword v126, v126, s[8:11], 0 offen
    buffer_load_dword v127, v127, s[8:11], 0 offen
    s_waitcnt vmcnt(16)
L3_lb2:
    s_bitcmp1_b32 s6, 2
    s_cbranch_scc1 L3_pd2
L3_pe2:
    s_bitcmp1_b32 s76, 8
    s_cbranch_scc1 L3_ps2_0
L3_pb2_0:
    v_mov_b32 v20, v21
    v_mov_b32 v22, v21
    s_bitcmp1_b32 s76, 9
    s_cbranch_scc1 L3_ps2_1
L3_pb2_1:
    v_mov_b32 v23, v21
    s_nop 1
    v_mfma_f32_4x4x4_16b_bf16 v[32:35], v[30:31], v[28:29], v[20:23] cbsz:4 abid:8
    v_rcp_f32 v82, v82
    v_mfma_f32_4x4x4_16b_bf16 v[36:39], v[30:31], v[28:29], v[20:23] cbsz:4 abid:9
    v_rcp_f32 v83, v83
    v_mfma_f32_4x4x4_16b_bf16 v[32:35], v[26:27], v[96:97], v[32:35]
    v_rcp_f32 v90, v90
    s_bitcmp1_b32 s76, 10
    s_cbranch_scc1 L3_ps2_2
L3_pb2_2:
    v_mov_b32 v20, v21
    v_mov_b32 v22, v21
    s_bitcmp1_b32 s76, 11
    s_cbranch_scc1 L3_ps2_3
L3_pb2_3:
    v_mov_b32 v23, v21
    s_nop 1
    v_mfma_f32_4x4x4_16b_bf16 v[40:43], v[30:31], v[28:29], v[20:23] cbsz:4 abid:10
    v_rcp_f32 v91, v91
    v_mfma_f32_4x4x4_16b_bf16 v[32:35], v[24:25], v[98:99], v[32:35]
    v_mfma_f32_4x4x4_16b_bf16 v[44:47], v[30:31], v[28:29], v[20:23] cbsz:4 abid:11
    v_mfma_f32_4x4x4_16b_bf16 v[36:39], v[26:27], v[100:101], v[36:39]
    v_mfma_f32_4x4x4_16b_bf16 v[40:43], v[26:27], v[104:105], v[40:43]
    v_mov_b32 v20, v21
    v_mov_b32 v22, v21
    s_bitcmp1_b32 s28, 9
    v_mfma_f32_4x4x4_16b_bf16 v[36:39], v[24:25], v[102:103], v[36:39]
    v_exp_f32_e64 v32, v32 clamp
    v_mfma_f32_4x4x4_16b_bf16 v[44:47], v[26:27], v[108:109], v[44:47]
    v_exp_f32_e64 v33, v33 clamp
    v_mfma_f32_4x4x4_16b_bf16 v[40:43], v[24:25], v[106:107], v[40:43]
    v_exp_f32_e64 v34, v34 clamp
    v_mfma_f32_4x4x4_16b_bf16 v[44:47], v[24:25], v[110:111], v[44:47]
    v_exp_f32_e64 v35, v35 clamp
    v_exp_f32_e64 v36, v36 clamp
    v_exp_f32_e64 v37, v37 clamp
    v_exp_f32_e64 v38, v38 clamp
    v_exp_f32_e64 v39, v39 clamp
    v_exp_f32_e64 v40, v40 clamp
    v_exp_f32_e64 v41, v41 clamp
    v_exp_f32_e64 v42, v42 clamp
    v_exp_f32_e64 v43, v43 clamp
    v_exp_f32_e64 v44, v44 clamp
    v_exp_f32_e64 v45, v45 clamp
    v_exp_f32_e64 v46, v46 clamp
    v_exp_f32_e64 v47, v47 clamp
    s_branch L3_xb2
L3_nl2:
    s_waitcnt vmcnt(0)
    s_branch L3_lb2
L3_pd2:
    s_sub_u32 s7, s7, 1
    s_setprio 0
    s_cmp_eq_u32 s7, 0
    s_cbranch_scc1 L3_pe2
    s_setprio 1
    s_cmp_eq_u32 s7, 1
    s_cbranch_scc1 L3_pe2
    s_setprio 2
    s_branch L3_pe2
L3_ps2_0:
    s_waitcnt lgkmcnt(0)
    v_mov_b32 v21, v48
    v_add_u32 v13, 0x100, v13
    ds_read_b32 v48, v13 offset:0
    s_branch L3_pb2_0
L3_ps2_1:
    s_waitcnt lgkmcnt(0)
    v_mov_b32 v21, v48
    v_add_u32 v13, 0x100, v13
    ds_read_b32 v48, v13 offset:0
    s_branch L3_pb2_1
L3_ps2_2:
    s_waitcnt lgkmcnt(0)
    v_mov_b32 v21, v48
    v_add_u32 v13, 0x100, v13
    ds_read_b32 v48, v13 offset:0
    s_branch L3_pb2_2
L3_ps2_3:
    s_waitcnt lgkmcnt(0)
    v_mov_b32 v21, v48
    v_add_u32 v13, 0x100, v13
    ds_read_b32 v48, v13 offset:0
    s_branch L3_pb2_3
L3_sf2:
    s_bitcmp1_b32 s4, 8
    s_cbranch_scc0 L3_sk2_0
    v_add_f32 v52, v18, v19
    v_mul_f32 v52, 0x30000000, v52
    v_cvt_f64_f32 v[16:17], v52
    ds_add_f64 v12, v[16:17] offset:13312
    v_add_u32 v12, 0x200, v12
    v_mov_b32 v18, 0
    v_mov_b32 v19, 0
L3_sk2_0:
    v_fmac_f32 v18, v80, v82
    s_bitcmp1_b32 s4, 9
    s_cbranch_scc0 L3_sk2_1
    v_add_f32 v52, v18, v19
    v_mul_f32 v52, 0x30000000, v52
    v_cvt_f64_f32 v[16:17], v52
    ds_add_f64 v12, v[16:17] offset:13312
    v_add_u32 v12, 0x200, v12
    v_mov_b32 v18, 0
    v_mov_b32 v19, 0
L3_sk2_1:
    v_fmac_f32 v19, v81, v83
    s_bitcmp1_b32 s4, 10
    s_cbranch_scc0 L3_sk2_2
    v_add_f32 v52, v18, v19
    v_mul_f32 v52, 0x30000000, v52
    v_cvt_f64_f32 v[16:17], v52
    ds_add_f64 v12, v[16:17] offset:13312
    v_add_u32 v12, 0x200, v12
    v_mov_b32 v18, 0
    v_mov_b32 v19, 0
L3_sk2_2:
    v_fmac_f32 v18, v88, v90
    s_bitcmp1_b32 s4, 11
    s_cbranch_scc0 L3_sk2_3
    v_add_f32 v52, v18, v19
    v_mul_f32 v52, 0x30000000, v52
    v_cvt_f64_f32 v[16:17], v52
    ds_add_f64 v12, v[16:17] offset:13312
    v_add_u32 v12, 0x200, v12
    v_mov_b32 v18, 0
    v_mov_b32 v19, 0
L3_sk2_3:
    v_fmac_f32 v19, v89, v91
    s_branch L3_fb2
L3_se3:
    s_bitcmp1_b32 s28, 15
    s_cbranch_scc1 L3_last2
    s_bitcmp1_b32 s28, 14
    s_waitcnt lgkmcnt(0)
    s_cbranch_scc1 L3_nl3
    buffer_load_dword v64, v64, s[8:11], 0 offen
    buffer_load_dword v65, v65, s[8:11], 0 offen
    buffer_load_dword v66, v66, s[8:11], 0 offen
    buffer_load_dword v67, v67, s[8:11], 0 offen
    buffer_load_dword v68, v68, s[8:11], 0 offen
    buffer_load_dword v69, v69, s[8:11], 0 offen
    buffer_load_dword v70, v70, s[8:11], 0 offen
    buffer_load_dword v71, v71, s[8:11], 0 offen
    buffer_load_dword v72, v72, s[8:11], 0 offen
    buffer_load_dword v73, v73, s[8:11], 0 offen
    buffer_load_dword v74, v74, s[8:11], 0 offen
    buffer_load_dword v75, v75, s[8:11], 0 offen
    buffer_load_dword v76, v76, s[8:11], 0 offen
    buffer_load_dword v77, v77, s[8:11], 0 offen
    buffer_load_dword v78, v78, s[8:11], 0 offen
    buffer_load_dword v79, v79, s[8:11], 0 offen
    s_waitcnt vmcnt(16)
L3_lb3:
    s_bitcmp1_b32 s6, 3
    s_cbranch_scc1 L3_pd3
L3_pe3:
    s_bitcmp1_b32 s76, 12
    s_cbranch_scc1 L3_ps3_0
L3_pb3_0:
    v_mov_b32 v20, v21
    v_mov_b32 v22, v21
    s_bitcmp1_b32 s76, 13
    s_cbranch_scc1 L3_ps3_1
L3_pb3_1:
    v_mov_b32 v23, v21
    s_nop 1
    v_mfma_f32_4x4x4_16b_bf16 v[32:35], v[30:31], v[28:29], v[20:23] cbsz:4 abid:12
    v_rcp_f32 v98, v98
    v_mfma_f32_4x4x4_16b_bf16 v[36:39], v[30:31], v[28:29], v[20:23] cbsz:4 abid:13
    v_rcp_f32 v99, v99
    v_mfma_f32_4x4x4_16b_bf16 v[32:35], v[26:27], v[112:113], v[32:35]
    v_rcp_f32 v106, v106
    s_bitcmp1_b32 s76, 14
    s_cbranch_scc1 L3_ps3_2
L3_pb3_2:
    v_mov_b32 v20, v21
    v_mov_b32 v22, v21
    s_bitcmp1_b32 s76, 15
    s_cbranch_scc1 L3_ps3_3
L3_pb3_3:
    v_mov_b32 v23, v21
    s_nop 1
    v_mfma_f32_4x4x4_16b_bf16 v[40:43], v[30:31], v[28:29], v[20:23] cbsz:4 abid:14
    v_rcp_f32 v107, v107
    v_mfma_f32_4x4x4_16b_bf16 v[32:35], v[24:25], v[114:115], v[32:35]
    v_mfma_f32_4x4x4_16b_bf16 v[44:47], v[30:31], v[28:29], v[20:23] cbsz:4 abid:15
    v_mfma_f32_4x4x4_16b_bf16 v[36:39], v[26:27], v[116:117], v[36:39]
    v_mfma_f32_4x4x4_16b_bf16 v[40:43], v[26:27], v[120:121], v[40:43]
    v_mov_b32 v20, v21
    v_mov_b32 v22, v21
    s_bitcmp1_b32 s28, 13
    v_mfma_f32_4x4x4_16b_bf16 v[36:39], v[24:25], v[118:119], v[36:39]
    v_exp_f32_e64 v32, v32 clamp
    v_mfma_f32_4x4x4_16b_bf16 v[44:47], v[26:27], v[124:125], v[44:47]
    v_exp_f32_e64 v33, v33 clamp
    v_mfma_f32_4x4x4_16b_bf16 v[40:43], v[24:25], v[122:123], v[40:43]
    v_exp_f32_e64 v34, v34 clamp
    v_mfma_f32_4x4x4_16b_bf16 v[44:47], v[24:25], v[126:127], v[44:47]
    v_exp_f32_e64 v35, v35 clamp
    v_exp_f32_e64 v36, v36 clamp
    v_exp_f32_e64 v37, v37 clamp
    v_exp_f32_e64 v38, v38 clamp
    v_exp_f32_e64 v39, v39 clamp
    v_exp_f32_e64 v40, v40 clamp
    v_exp_f32_e64 v41, v41 clamp
    v_exp_f32_e64 v42, v42 clamp
    v_exp_f32_e64 v43, v43 clamp
    v_exp_f32_e64 v44, v44 clamp
    v_exp_f32_e64 v45, v45 clamp
    v_exp_f32_e64 v46, v46 clamp
    v_exp_f32_e64 v47, v47 clamp
    s_branch L3_xb3
L3_nl3:
    s_waitcnt vmcnt(0)
    s_branch L3_lb3
L3_pd3:
    s_sub_u32 s7, s7, 1
    s_setprio 0
    s_cmp_eq_u32 s7, 0
    s_cbranch_scc1 L3_pe3
    s_setprio 1
    s_cmp_eq_u32 s7, 1
    s_cbranch_scc1 L3_pe3
    s_setprio 2
    s_branch L3_pe3
L3_ps3_0:
    s_waitcnt lgkmcnt(0)
    v_mov_b32 v21, v48
    v_add_u32 v13, 0x100, v13
    ds_read_b32 v48, v13 offset:0
    s_branch L3_pb3_0
L3_ps3_1:
    s_waitcnt lgkmcnt(0)
    v_mov_b32 v21, v48
    v_add_u32 v13, 0x100, v13
    ds_read_b32 v48, v13 offset:0
    s_branch L3_pb3_1
L3_ps3_2:
    s_waitcnt lgkmcnt(0)
    v_mov_b32 v21, v48
    v_add_u32 v13, 0x100, v13
    ds_read_b32 v48, v13 offset:0
    s_branch L3_pb3_2
L3_ps3_3:
    s_waitcnt lgkmcnt(0)
    v_mov_b32 v21, v48
    v_add_u32 v13, 0x100, v13
    ds_read_b32 v48, v13 offset:0
    s_branch L3_pb3_3
L3_sf3:
    s_bitcmp1_b32 s4, 12
    s_cbranch_scc0 L3_sk3_0
    v_add_f32 v52, v18, v19
    v_mul_f32 v52, 0x30000000, v52
    v_cvt_f64_f32 v[16:17], v52
    ds_add_f64 v12, v[16:17] offset:13312
    v_add_u32 v12, 0x200, v12
    v_mov_b32 v18, 0
    v_mov_b32 v19, 0
L3_sk3_0:
    v_fmac_f32 v18, v96, v98
    s_bitcmp1_b32 s4, 13
    s_cbranch_scc0 L3_sk3_1
    v_add_f32 v52, v18, v19
    v_mul_f32 v52, 0x30000000, v52
    v_cvt_f64_f32 v[16:17], v52
    ds_add_f64 v12, v[16:17] offset:13312
    v_add_u32 v12, 0x200, v12
    v_mov_b32 v18, 0
    v_mov_b32 v19, 0
L3_sk3_1:
    v_fmac_f32 v19, v97, v99
    s_bitcmp1_b32 s4, 14
    s_cbranch_scc0 L3_sk3_2
    v_add_f32 v52, v18, v19
    v_mul_f32 v52, 0x30000000, v52
    v_cvt_f64_f32 v[16:17], v52
    ds_add_f64 v12, v[16:17] offset:13312
    v_add_u32 v12, 0x200, v12
    v_mov_b32 v18, 0
    v_mov_b32 v19, 0
L3_sk3_2:
    v_fmac_f32 v18, v104, v106
    s_bitcmp1_b32 s4, 15
    s_cbranch_scc0 L3_sk3_3
    v_add_f32 v52, v18, v19
    v_mul_f32 v52, 0x30000000, v52
    v_cvt_f64_f32 v[16:17], v52
    ds_add_f64 v12, v[16:17] offset:13312
    v_add_u32 v12, 0x200, v12
    v_mov_b32 v18, 0
    v_mov_b32 v19, 0
L3_sk3_3:
    v_fmac_f32 v19, v105, v107
    s_branch L3_fb3
L3_sfe0:
    s_bitcmp1_b32 s23, 0
    s_cbranch_scc0 L3_ske0_0
    v_add_f32 v52, v18, v19
    v_mul_f32 v52, 0x30000000, v52
    v_cvt_f64_f32 v[16:17], v52
    ds_add_f64 v12, v[16:17] offset:13312
    v_add_u32 v12, 0x200, v12
    v_mov_b32 v18, 0
    v_mov_b32 v19, 0
L3_ske0_0:
    v_fmac_f32 v18, v64, v66
    s_bitcmp1_b32 s23, 1
    s_cbranch_scc0 L3_ske0_1
    v_add_f32 v52, v18, v19
    v_mul_f32 v52, 0x30000000, v52
    v_cvt_f64_f32 v[16:17], v52
    ds_add_f64 v12, v[16:17] offset:13312
    v_add_u32 v12, 0x200, v12
    v_mov_b32 v18, 0
    v_mov_b32 v19, 0
L3_ske0_1:
    v_fmac_f32 v19, v65, v67
    s_bitcmp1_b32 s23, 2
    s_cbranch_scc0 L3_ske0_2
    v_add_f32 v52, v18, v19
    v_mul_f32 v52, 0x30000000, v52
    v_cvt_f64_f32 v[16:17], v52
    ds_add_f64 v12, v[16:17] offset:13312
    v_add_u32 v12, 0x200, v12
    v_mov_b32 v18, 0
    v_mov_b32 v19, 0
L3_ske0_2:
    v_fmac_f32 v18, v72, v74
    s_bitcmp1_b32 s23, 3
    s_cbranch_scc0 L3_ske0_3
    v_add_f32 v52, v18, v19
    v_mul_f32 v52, 0x30000000, v52
    v_cvt_f64_f32 v[16:17], v52
    ds_add_f64 v12, v[16:17] offset:13312
    v_add_u32 v12, 0x200, v12
    v_mov_b32 v18, 0
    v_mov_b32 v19, 0
L3_ske0_3:
    v_fmac_f32 v19, v73, v75
    s_branch L3_fbe0
L3_last1:
    v_rcp_f32 v82, v82
    v_rcp_f32 v83, v83
    v_rcp_f32 v90, v90
    v_rcp_f32 v91, v91
    s_cmp_lg_u32 s23, 0
    s_cbranch_scc1 L3_sfe1
    v_pk_fma_f32 v[18:19], v[80:81], v[82:83], v[18:19]
    v_pk_fma_f32 v[18:19], v[88:89], v[90:91], v[18:19]
L3_fbe1:
    s_branch L2_last
L3_sfe1:
    s_bitcmp1_b32 s23, 0
    s_cbranch_scc0 L3_ske1_0
    v_add_f32 v52, v18, v19
    v_mul_f32 v52, 0x30000000, v52
    v_cvt_f64_f32 v[16:17], v52
    ds_add_f64 v12, v[16:17] offset:13312
    v_add_u32 v12, 0x200, v12
    v_mov_b32 v18, 0
    v_mov_b32 v19, 0
L3_ske1_0:
    v_fmac_f32 v18, v80, v82
    s_bitcmp1_b32 s23, 1
    s_cbranch_scc0 L3_ske1_1
    v_add_f32 v52, v18, v19
    v_mul_f32 v52, 0x30000000, v52
    v_cvt_f64_f32 v[16:17], v52
    ds_add_f64 v12, v[16:17] offset:13312
    v_add_u32 v12, 0x200, v12
    v_mov_b32 v18, 0
    v_mov_b32 v19, 0
L3_ske1_1:
    v_fmac_f32 v19, v81, v83
    s_bitcmp1_b32 s23, 2
    s_cbranch_scc0 L3_ske1_2
    v_add_f32 v52, v18, v19
    v_mul_f32 v52, 0x30000000, v52
    v_cvt_f64_f32 v[16:17], v52
    ds_add_f64 v12, v[16:17] offset:13312
    v_add_u32 v12, 0x200, v12
    v_mov_b32 v18, 0
    v_mov_b32 v19, 0
L3_ske1_2:
    v_fmac_f32 v18, v88, v90
    s_bitcmp1_b32 s23, 3
    s_cbranch_scc0 L3_ske1_3
    v_add_f32 v52, v18, v19
    v_mul_f32 v52, 0x30000000, v52
    v_cvt_f64_f32 v[16:17], v52
    ds_add_f64 v12, v[16:17] offset:13312
    v_add_u32 v12, 0x200, v12
    v_mov_b32 v18, 0
    v_mov_b32 v19, 0
L3_ske1_3:
    v_fmac_f32 v19, v89, v91
    s_branch L3_fbe1
L3_last2:
    v_rcp_f32 v98, v98
    v_rcp_f32 v99, v99
    v_rcp_f32 v106, v106
    v_rcp_f32 v107, v107
    s_cmp_lg_u32 s23, 0
    s_cbranch_scc1 L3_sfe2
    v_pk_fma_f32 v[18:19], v[96:97], v[98:99], v[18:19]
    v_pk_fma_f32 v[18:19], v[104:105], v[106:107], v[18:19]
L3_fbe2:
    s_branch L2_last
L3_sfe2:
    s_bitcmp1_b32 s23, 0
    s_cbranch_scc0 L3_ske2_0
    v_add_f32 v52, v18, v19
    v_mul_f32 v52, 0x30000000, v52
    v_cvt_f64_f32 v[16:17], v52
    ds_add_f64 v12, v[16:17] offset:13312
    v_add_u32 v12, 0x200, v12
    v_mov_b32 v18, 0
    v_mov_b32 v19, 0
L3_ske2_0:
    v_fmac_f32 v18, v96, v98
    s_bitcmp1_b32 s23, 1
    s_cbranch_scc0 L3_ske2_1
    v_add_f32 v52, v18, v19
    v_mul_f32 v52, 0x30000000, v52
    v_cvt_f64_f32 v[16:17], v52
    ds_add_f64 v12, v[16:17] offset:13312
    v_add_u32 v12, 0x200, v12
    v_mov_b32 v18, 0
    v_mov_b32 v19, 0
L3_ske2_1:
    v_fmac_f32 v19, v97, v99
    s_bitcmp1_b32 s23, 2
    s_cbranch_scc0 L3_ske2_2
    v_add_f32 v52, v18, v19
    v_mul_f32 v52, 0x30000000, v52
    v_cvt_f64_f32 v[16:17], v52
    ds_add_f64 v12, v[16:17] offset:13312
    v_add_u32 v12, 0x200, v12
    v_mov_b32 v18, 0
    v_mov_b32 v19, 0
L3_ske2_2:
    v_fmac_f32 v18, v104, v106
    s_bitcmp1_b32 s23, 3
    s_cbranch_scc0 L3_ske2_3
    v_add_f32 v52, v18, v19
    v_mul_f32 v52, 0x30000000, v52
    v_cvt_f64_f32 v[16:17], v52
    ds_add_f64 v12, v[16:17] offset:13312
    v_add_u32 v12, 0x200, v12
    v_mov_b32 v18, 0
    v_mov_b32 v19, 0
L3_ske2_3:
    v_fmac_f32 v19, v105, v107
    s_branch L3_fbe2
L3_last3:
    v_rcp_f32 v114, v114
    v_rcp_f32 v115, v115
    v_rcp_f32 v122, v122
    v_rcp_f32 v123, v123
    s_cmp_lg_u32 s23, 0
    s_cbranch_scc1 L3_sfe3
    v_pk_fma_f32 v[18:19], v[112:113], v[114:115], v[18:19]
    v_pk_fma_f32 v[18:19], v[120:121], v[122:123], v[18:19]
L3_fbe3:
    s_branch L2_last
L3_sfe3:
    s_bitcmp1_b32 s23, 0
    s_cbranch_scc0 L3_ske3_0
    v_add_f32 v52, v18, v19
    v_mul_f32 v52, 0x30000000, v52
    v_cvt_f64_f32 v[16:17], v52
    ds_add_f64 v12, v[16:17] offset:13312
    v_add_u32 v12, 0x200, v12
    v_mov_b32 v18, 0
    v_mov_b32 v19, 0
L3_ske3_0:
    v_fmac_f32 v18, v112, v114
    s_bitcmp1_b32 s23, 1
    s_cbranch_scc0 L3_ske3_1
    v_add_f32 v52, v18, v19
    v_mul_f32 v52, 0x30000000, v52
    v_cvt_f64_f32 v[16:17], v52
    ds_add_f64 v12, v[16:17] offset:13312
    v_add_u32 v12, 0x200, v12
    v_mov_b32 v18, 0
    v_mov_b32 v19, 0
L3_ske3_1:
    v_fmac_f32 v19, v113, v115
    s_bitcmp1_b32 s23, 2
    s_cbranch_scc0 L3_ske3_2
    v_add_f32 v52, v18, v19
    v_mul_f32 v52, 0x30000000, v52
    v_cvt_f64_f32 v[16:17], v52
    ds_add_f64 v12, v[16:17] offset:13312
    v_add_u32 v12, 0x200, v12
    v_mov_b32 v18, 0
    v_mov_b32 v19, 0
L3_ske3_2:
    v_fmac_f32 v18, v120, v122
    s_bitcmp1_b32 s23, 3
    s_cbranch_scc0 L3_ske3_3
    v_add_f32 v52, v18, v19
    v_mul_f32 v52, 0x30000000, v52
    v_cvt_f64_f32 v[16:17], v52
    ds_add_f64 v12, v[16:17] offset:13312
    v_add_u32 v12, 0x200, v12
    v_mov_b32 v18, 0
    v_mov_b32 v19, 0
L3_ske3_3:
    v_fmac_f32 v19, v121, v123
    s_branch L3_fbe3
L2_next:
    v_mov_b32 v3, 0
    ds_write_b32 v1, v3
    ds_write_b32 v2, v3 offset:256
    s_waitcnt lgkmcnt(0)
    s_barrier
    s_cmp_lg_u32 s20, 0
    s_cbranch_scc1 L2_again
    s_add_u32 s21, s21, 32
    s_branch L2_pass
L_codeend:
.section .rodata,"a"
.p2align 6
.amdhsa_kernel standalone__edge_featured_mpnn_egc__graph_kernel
  .amdhsa_next_free_vgpr 128
  .amdhsa_next_free_sgpr 102
  .amdhsa_accum_offset 128
  .amdhsa_group_segment_fixed_size 0
  .amdhsa_kernarg_size 80
  .amdhsa_user_sgpr_count 2
  .amdhsa_user_sgpr_kernarg_segment_ptr 1
  .amdhsa_system_sgpr_workgroup_id_x 1
  .amdhsa_float_denorm_mode_32 3
  .amdhsa_dx10_clamp 0
.end_amdhsa_kernel
```
